```python
import torch

def _softmax(x, axis=-1):
    return torch.softmax(x, dim=axis)
def _gelu(x):
    return torch.nn.functional.gelu(x, approximate="tanh")
def _silu(x):
    return torch.nn.functional.silu(x)
def _sigmoid(x):
    return torch.sigmoid(x)
def _layernorm(x, axis=-1, eps=1e-5):
    m = x.mean(dim=axis, keepdim=True)
    v = x.var(dim=axis, keepdim=True, unbiased=False)
    return (x - m) / torch.sqrt(v + eps)
def _scatter_add(tgt, idx, src, axis=0):
    return tgt.clone().index_add_(axis, idx, src)
def _segment_sum(src, seg, n):
    out = torch.zeros((n,) + src.shape[1:], dtype=src.dtype)
    return out.index_add_(0, seg, src)
def _pad(x, pw):
    flat = tuple(v for pair in reversed(pw) for v in pair)
    return torch.nn.functional.pad(x, flat)

kernel_name = 'recurrent_scan__linear_attn_block__dense_activation_silu__prompt'

def setup_inputs():

    _w = (lambda a: (lambda t: t.to(torch.bfloat16) if t.is_floating_point() else t)(torch.as_tensor(a)))
    def _A_setup():
        B, S, D = 1, 2048, 512
        return {
            "x": _w((lambda *s: torch.randn(*s, dtype=torch.bfloat16) * 0.05)(B, S, D)),
            "wqkv": _w((lambda *s: torch.randn(*s, dtype=torch.bfloat16) * 0.2)(D, 3 * D)),
            "wo": _w((lambda *s: torch.randn(*s, dtype=torch.bfloat16) * 0.2)(D, D)),
        }
    _A_in = _A_setup()

    def _B_setup():
        B, S, D, F = 1, 2048, 512, 1792
        return {
            "x": _w((lambda *s: torch.randn(*s, dtype=torch.bfloat16) * 0.05)(B, S, D)),
            "w1": _w((lambda *s: torch.randn(*s, dtype=torch.bfloat16) * 0.8)(D, F) * (D ** -0.5)),
            "w2": _w((lambda *s: torch.randn(*s, dtype=torch.bfloat16) * 0.1)(F, D) * (F ** -0.5)),
        }
    _B_in = _B_setup()

    return {
        "A_x": _A_in["x"],
        "A_wqkv": _A_in["wqkv"],
        "A_wo": _A_in["wo"],
        "B_x": _B_in["x"],
        "B_w1": _B_in["w1"],
        "B_w2": _B_in["w2"],
    }

def reference(A_x, A_wqkv, A_wo, B_x, B_w1, B_w2):
    def _A_ref(x, wqkv, wo):
        B, S, D = x.shape
        H = 32; Dh = D // H
        qkv = (lambda x, *d: x.permute(*d))((x @ wqkv).reshape(B, S, 3, H, Dh), 2, 0, 3, 1, 4)
        q, k, v = qkv[0], qkv[1], qkv[2]
        phi = lambda t: torch.where(t > 0, t + 1, torch.exp(t)) + 1e-6
        pq, pk = phi(q), phi(k)
        kv = torch.einsum("bhsd,bhse->bhde", pk, v)
        z = torch.einsum("bhsd->bhd", pk)
        num = torch.einsum("bhqd,bhde->bhqe", pq, kv)
        den = torch.einsum("bhqd,bhd->bhq", pq, z)[..., None] + 1e-6
        o = num / den
        return (lambda x, *d: x.permute(*d))(o, 0, 2, 1, 3).reshape(B, S, D) @ wo

    def _B_ref(x, w1, w2):
        h = torch.einsum("bsd,df->bsf", x, w1)
        h = _silu(h)
        out = torch.einsum("bsf,fd->bsd", h, w2)
        return out

    x = A_x
    xn = _layernorm(x, axis=-1)
    s = _A_ref(xn, A_wqkv, A_wo)
    g = _silu(_B_ref(xn, B_w1, B_w2))
    return x + s * g
```

```asm
; @launch grid=(256,1,1) block=(512,1,1) lds=163840
.amdgcn_target "amdgcn-amd-amdhsa--gfx950"
.text
.globl recurrent_scan__linear_attn_block__dense_activation_silu__prompt_kernel
.p2align 8
.type recurrent_scan__linear_attn_block__dense_activation_silu__prompt_kernel,@function
recurrent_scan__linear_attn_block__dense_activation_silu__prompt_kernel:
  s_cmp_ge_u32 s2, 256
  s_cbranch_scc1 L_end
  s_load_dwordx4 s[76:79], s[0:1], 0
  s_load_dwordx4 s[84:87], s[0:1], 32
  s_load_dwordx2 s[92:93], s[0:1], 64
  s_load_dwordx2 s[80:81], s[0:1], 16
  s_load_dwordx4 s[88:91], s[0:1], 48
  v_and_b32 v1, 63, v0
  v_lshrrev_b32 v2, 6, v0
  s_getpc_b64 s[94:95]
L_pc:
  s_lshr_b32 s3, s2, 3
  s_mul_i32 s3, s3, (L_end-L_pc+4095)/4096*128
  v_lshlrev_b32 v14, 7, v0
  v_add_u32 v14, s3, v14
  v_min_u32 v14, L_end-L_pc, v14
  v_cmp_gt_u32 vcc, (L_end-L_pc+4095)/4096, v0
  s_nop 0
  s_and_saveexec_b64 s[98:99], vcc
  s_cbranch_execz L_nopf
  global_load_dword v15, v14, s[94:95]
L_nopf:
  s_mov_b64 exec, s[98:99]
  v_readfirstlane_b32 s32, v2
  s_and_b32 s40, s2, 7
  s_lshr_b32 s41, s2, 3
  s_and_b32 s42, s40, 1
  s_lshl_b32 s42, s42, 3
  s_and_b32 s43, s41, 7
  s_add_u32 s34, s42, s43
  s_lshr_b32 s43, s41, 3
  s_lshr_b32 s36, s43, 1
  s_lshr_b32 s42, s40, 1
  s_lshl_b32 s42, s42, 1
  s_and_b32 s44, s43, 1
  s_add_u32 s35, s42, s44
  s_lshl_b32 s44, s43, 1
  s_add_u32 s37, s34, s44
  s_and_b32 s37, s37, 7
  s_and_b32 s33, s32, 3
  s_mul_i32 s40, s35, 224
  s_and_b32 s41, s35, 1
  s_mul_i32 s42, s41, 96
  s_add_u32 s58, s40, s42
  s_xor_b32 s41, s41, 1
  s_lshl_b32 s41, s41, 7
  s_add_u32 s59, s40, s41
  s_lshl_b32 s40, s35, 6
  s_add_u32 s41, s40, 512
  s_cmp_eq_u32 s36, 0
  s_cselect_b32 s58, s58, s41
  s_cselect_b32 s59, s59, s40
  s_mov_b32 s40, 3584
  s_mov_b32 s41, 3072
  s_cselect_b32 s38, s40, s41
  s_mov_b32 s40, 1835008
  s_mov_b32 s41, 1572864
  s_cselect_b32 s10, s40, s41
  s_mov_b32 s11, 0x20000
  s_lshl_b32 s54, s38, 6
  s_waitcnt lgkmcnt(0)
  s_cmp_eq_u32 s36, 0
  s_cselect_b32 s8, s84, s78
  s_cselect_b32 s9, s85, s79
  s_mov_b32 s4, s76
  s_mov_b32 s5, s77
  s_mov_b32 s6, 2097152
  s_mov_b32 s7, 0x20000
  s_cmp_ge_u32 s32, 4
  s_cbranch_scc0 L_A
  s_cmp_eq_u32 s36, 0
  s_cbranch_scc0 L_BQ
  v_lshrrev_b32 v2, 3, v1
  v_lshlrev_b32 v5, 10, v2
  v_and_b32 v3, 7, v1
  v_lshrrev_b32 v4, 4, v1
  v_xor_b32 v6, v3, v4
  v_lshlrev_b32 v6, 4, v6
  v_add_u32 v104, v5, v6
  v_xor_b32 v105, 64, v104
  v_mul_lo_u32 v2, v2, s38
  v_and_b32 v4, 1, v4
  v_lshlrev_b32 v4, 2, v4
  v_xor_b32 v3, v3, v4
  v_lshlrev_b32 v3, 4, v3
  v_add_u32 v106, v2, v3
  v_mov_b32 v48, v104
  v_add_u32 v49, 7168, v105
  v_add_u32 v50, 14336, v104
  v_add_u32 v51, 21504, v105
  s_lshl_b32 s45, s38, 3
  s_sub_u32 s45, s45, 1024
  v_mov_b32 v52, v106
  v_add_u32 v53, s45, v52
  v_add_u32 v54, s45, v53
  v_add_u32 v55, s45, v54
  s_lshl_b32 s40, s34, 7
  s_lshl_b32 s41, s33, 5
  s_add_u32 s40, s40, s41
  s_lshl_b32 s46, s40, 10
  s_lshl_b32 s48, s33, 12
  s_lshr_b32 s40, s33, 1
  s_and_b32 s41, s33, 1
  s_lshl_b32 s42, s41, 5
  s_mul_i32 s42, s42, s38
  s_lshl_b32 s43, s58, 1
  s_lshl_b32 s44, s40, 7
  s_add_u32 s43, s43, s44
  s_add_u32 s47, s42, s43
  s_lshl_b32 s42, s40, 13
  s_lshl_b32 s43, s41, 12
  s_add_u32 s49, s42, s43
  s_add_u32 s49, s49, 16384
  s_add_u32 s40, s37, 0
  s_and_b32 s40, s40, 7
  s_lshl_b32 s41, s40, 7
  s_add_u32 s50, s46, s41
  s_mul_i32 s41, s40, s54
  s_add_u32 s51, s47, s41
  s_add_u32 m0, s48, 0
  s_nop 0
  buffer_load_dwordx4 v48, s[4:7], s50 offen offset:0 lds
  buffer_load_dwordx4 v49, s[4:7], s50 offen offset:1024 lds
  buffer_load_dwordx4 v50, s[4:7], s50 offen offset:2048 lds
  buffer_load_dwordx4 v51, s[4:7], s50 offen offset:3072 lds
  s_add_u32 m0, s49, 0
  s_nop 0
  buffer_load_dwordx4 v52, s[8:11], s51 offen offset:0 lds
  buffer_load_dwordx4 v53, s[8:11], s51 offen offset:1024 lds
  buffer_load_dwordx4 v54, s[8:11], s51 offen offset:2048 lds
  buffer_load_dwordx4 v55, s[8:11], s51 offen offset:3072 lds
  s_add_u32 s40, s37, 1
  s_and_b32 s40, s40, 7
  s_lshl_b32 s41, s40, 7
  s_add_u32 s50, s46, s41
  s_mul_i32 s41, s40, s54
  s_add_u32 s51, s47, s41
  s_add_u32 m0, s48, 32768
  s_nop 0
  buffer_load_dwordx4 v48, s[4:7], s50 offen offset:0 lds
  buffer_load_dwordx4 v49, s[4:7], s50 offen offset:1024 lds
  buffer_load_dwordx4 v50, s[4:7], s50 offen offset:2048 lds
  buffer_load_dwordx4 v51, s[4:7], s50 offen offset:3072 lds
  s_add_u32 m0, s49, 32768
  s_nop 0
  buffer_load_dwordx4 v52, s[8:11], s51 offen offset:0 lds
  buffer_load_dwordx4 v53, s[8:11], s51 offen offset:1024 lds
  buffer_load_dwordx4 v54, s[8:11], s51 offen offset:2048 lds
  buffer_load_dwordx4 v55, s[8:11], s51 offen offset:3072 lds
  s_add_u32 s40, s37, 2
  s_and_b32 s40, s40, 7
  s_lshl_b32 s41, s40, 7
  s_add_u32 s50, s46, s41
  s_mul_i32 s41, s40, s54
  s_add_u32 s51, s47, s41
  s_add_u32 m0, s48, 65536
  s_nop 0
  buffer_load_dwordx4 v48, s[4:7], s50 offen offset:0 lds
  buffer_load_dwordx4 v49, s[4:7], s50 offen offset:1024 lds
  buffer_load_dwordx4 v50, s[4:7], s50 offen offset:2048 lds
  buffer_load_dwordx4 v51, s[4:7], s50 offen offset:3072 lds
  s_add_u32 m0, s49, 65536
  s_nop 0
  buffer_load_dwordx4 v52, s[8:11], s51 offen offset:0 lds
  buffer_load_dwordx4 v53, s[8:11], s51 offen offset:1024 lds
  buffer_load_dwordx4 v54, s[8:11], s51 offen offset:2048 lds
  buffer_load_dwordx4 v55, s[8:11], s51 offen offset:3072 lds
  s_mov_b32 s12, s92
  s_mov_b32 s13, s93
  s_mov_b32 s14, 16777216
  s_mov_b32 s15, 0x20000
  s_mov_b32 s16, s86
  s_mov_b32 s17, s87
  s_mov_b32 s18, 1835008
  s_mov_b32 s19, 0x20000
  s_mov_b32 s20, s80
  s_mov_b32 s21, s81
  s_mov_b32 s22, 524288
  s_mov_b32 s23, 0x20000
  s_mov_b32 s24, s88
  s_mov_b32 s25, s89
  s_mov_b32 s26, 2097152
  s_mov_b32 s27, 0x20000
  s_mov_b32 s28, s90
  s_mov_b32 s29, s91
  s_mov_b32 s30, 256
  s_mov_b32 s31, 0x20000
  s_mov_b32 s70, 0x3f317218
  s_mov_b32 s71, 0x35c1a2a0
  v_and_b32 v2, 31, v1
  v_lshrrev_b32 v3, 5, v1
  v_lshrrev_b32 v4, 1, v2
  v_and_b32 v4, 7, v4
  v_xor_b32 v4, v4, v3
  v_lshlrev_b32 v4, 4, v4
  v_lshlrev_b32 v5, 7, v2
  v_add_u32 v4, v4, v5
  v_add_u32 v4, s48, v4
  v_xor_b32 v110, 0, v4
  v_xor_b32 v111, 32, v4
  v_xor_b32 v112, 64, v4
  v_xor_b32 v113, 96, v4
  s_lshl_b32 s40, s33, 4
  s_mul_i32 s40, s40, s38
  s_lshl_b32 s41, s59, 1
  s_add_u32 s52, s40, s41
  v_add_u32 v2, 0, v1
  s_mov_b32 s40, 43691
  v_mul_lo_u32 v3, v2, s40
  v_lshrrev_b32 v3, 19, v3
  v_mul_u32_u24 v4, 12, v3
  v_sub_u32 v4, v2, v4
  v_lshlrev_b32 v4, 4, v4
  v_mul_lo_u32 v3, v3, s38
  v_add_u32 v107, v3, v4
  v_add_u32 v2, 64, v1
  s_mov_b32 s40, 43691
  v_mul_lo_u32 v3, v2, s40
  v_lshrrev_b32 v3, 19, v3
  v_mul_u32_u24 v4, 12, v3
  v_sub_u32 v4, v2, v4
  v_lshlrev_b32 v4, 4, v4
  v_mul_lo_u32 v3, v3, s38
  v_add_u32 v108, v3, v4
  v_subrev_u32 v108, 1024, v108
  v_add_u32 v2, 128, v1
  s_mov_b32 s40, 43691
  v_mul_lo_u32 v3, v2, s40
  v_lshrrev_b32 v3, 19, v3
  v_mul_u32_u24 v4, 12, v3
  v_sub_u32 v4, v2, v4
  v_lshlrev_b32 v4, 4, v4
  v_mul_lo_u32 v3, v3, s38
  v_add_u32 v109, v3, v4
  v_subrev_u32 v109, 2048, v109
  s_mul_i32 s53, s33, 3072
  v_lshrrev_b32 v2, 5, v1
  v_lshlrev_b32 v2, 3, v2
  v_and_b32 v3, 15, v1
  v_lshrrev_b32 v4, 2, v3
  v_add_u32 v2, v2, v4
  v_mul_u32_u24 v2, 192, v2
  v_lshrrev_b32 v4, 4, v1
  v_and_b32 v4, 1, v4
  v_lshlrev_b32 v4, 5, v4
  v_add_u32 v2, v2, v4
  v_and_b32 v4, 3, v3
  v_lshlrev_b32 v4, 3, v4
  v_add_u32 v2, v2, v4
  s_add_u32 s40, s33, 0
  s_cmp_ge_u32 s40, 3
  s_cselect_b32 s41, 3, 0
  s_sub_u32 s40, s40, s41
  s_cmp_ge_u32 s40, 3
  s_cselect_b32 s41, 3, 0
  s_sub_u32 s40, s40, s41
  s_lshl_b32 s40, s40, 6
  v_add_u32 v114, s40, v2
  s_add_u32 s40, s33, 1
  s_cmp_ge_u32 s40, 3
  s_cselect_b32 s41, 3, 0
  s_sub_u32 s40, s40, s41
  s_cmp_ge_u32 s40, 3
  s_cselect_b32 s41, 3, 0
  s_sub_u32 s40, s40, s41
  s_lshl_b32 s40, s40, 6
  v_add_u32 v115, s40, v2
  s_add_u32 s40, s33, 2
  s_cmp_ge_u32 s40, 3
  s_cselect_b32 s41, 3, 0
  s_sub_u32 s40, s40, s41
  s_cmp_ge_u32 s40, 3
  s_cselect_b32 s41, 3, 0
  s_sub_u32 s40, s40, s41
  s_lshl_b32 s40, s40, 6
  v_add_u32 v116, s40, v2
  v_and_b32 v2, 15, v1
  v_lshrrev_b32 v3, 4, v1
  v_and_b32 v3, 1, v3
  v_cmp_eq_u32 vcc, v2, v3
  v_mov_b32 v2, 0x3f803f80
  s_nop 0
  v_cndmask_b32 v118, 0, v2, vcc
  v_mov_b32 v119, v118
  v_mov_b32 v120, v118
  v_mov_b32 v121, v118
  s_lshl_b32 s43, s34, 11
  s_lshl_b32 s44, s33, 9
  s_add_u32 s43, s43, s44
  s_add_u32 s43, s43, 196608
  v_and_b32 v2, 31, v1
  v_lshlrev_b32 v2, 4, v2
  v_add_u32 v16, s43, v2
  s_lshl_b32 s42, s36, 3
  s_add_u32 s42, s42, s35
  s_lshl_b32 s43, s42, 14
  s_add_u32 s43, s43, 262144
  s_lshl_b32 s44, s33, 8
  s_add_u32 s43, s43, s44
  v_lshrrev_b32 v2, 5, v1
  v_lshlrev_b32 v2, 13, v2
  v_and_b32 v3, 31, v1
  v_lshlrev_b32 v3, 3, v3
  v_add_u32 v2, v2, v3
  v_add_u32 v17, s43, v2
  s_mov_b32 s56, 4096
  s_waitcnt vmcnt(16) lgkmcnt(0)
  s_barrier
  v_add_u32 v124, 0, v110
  ds_read_b128 v[128:131], v124
  v_add_u32 v125, 0, v111
  ds_read_b128 v[132:135], v125
  v_add_u32 v126, 0, v112
  ds_read_b128 v[136:139], v126
  v_add_u32 v127, 0, v113
  ds_read_b128 v[140:143], v127
  v_mov_b32 v3, 157680
  ds_read_b32 v4, v3
  s_waitcnt lgkmcnt(0)
  v_readfirstlane_b32 s1, v4
  s_add_u32 s40, s37, 3
  s_and_b32 s40, s40, 7
  s_lshl_b32 s41, s40, 7
  s_add_u32 s50, s46, s41
  s_mul_i32 s41, s40, s54
  s_add_u32 s51, s47, s41
  s_add_u32 m0, s48, 98304
  s_nop 0
  buffer_load_dwordx4 v48, s[4:7], s50 offen offset:0 lds
  buffer_load_dwordx4 v49, s[4:7], s50 offen offset:1024 lds
  buffer_load_dwordx4 v50, s[4:7], s50 offen offset:2048 lds
  buffer_load_dwordx4 v51, s[4:7], s50 offen offset:3072 lds
  s_add_u32 m0, s49, 98304
  s_nop 0
  buffer_load_dwordx4 v52, s[8:11], s51 offen offset:0 lds
  buffer_load_dwordx4 v53, s[8:11], s51 offen offset:1024 lds
  buffer_load_dwordx4 v54, s[8:11], s51 offen offset:2048 lds
  buffer_load_dwordx4 v55, s[8:11], s51 offen offset:3072 lds
  s_waitcnt vmcnt(16) lgkmcnt(0)
  s_barrier
  v_add_u32 v124, 32768, v110
  ds_read_b128 v[144:147], v124
  v_add_u32 v125, 32768, v111
  ds_read_b128 v[148:151], v125
  v_add_u32 v126, 32768, v112
  ds_read_b128 v[152:155], v126
  v_add_u32 v127, 32768, v113
  ds_read_b128 v[156:159], v127
  s_add_u32 s40, s37, 4
  s_and_b32 s40, s40, 7
  s_lshl_b32 s41, s40, 7
  s_add_u32 s50, s46, s41
  s_mul_i32 s41, s40, s54
  s_add_u32 s51, s47, s41
  s_add_u32 m0, s48, 0
  s_nop 0
  buffer_load_dwordx4 v48, s[4:7], s50 offen offset:0 lds
  buffer_load_dwordx4 v49, s[4:7], s50 offen offset:1024 lds
  buffer_load_dwordx4 v50, s[4:7], s50 offen offset:2048 lds
  buffer_load_dwordx4 v51, s[4:7], s50 offen offset:3072 lds
  s_add_u32 m0, s49, 0
  s_nop 0
  buffer_load_dwordx4 v52, s[8:11], s51 offen offset:0 lds
  buffer_load_dwordx4 v53, s[8:11], s51 offen offset:1024 lds
  buffer_load_dwordx4 v54, s[8:11], s51 offen offset:2048 lds
  buffer_load_dwordx4 v55, s[8:11], s51 offen offset:3072 lds
  s_waitcnt vmcnt(16) lgkmcnt(0)
  s_barrier
  v_add_u32 v124, 65536, v110
  ds_read_b128 v[160:163], v124
  v_add_u32 v125, 65536, v111
  ds_read_b128 v[164:167], v125
  v_add_u32 v126, 65536, v112
  ds_read_b128 v[168:171], v126
  v_add_u32 v127, 65536, v113
  ds_read_b128 v[172:175], v127
  s_add_u32 s40, s37, 5
  s_and_b32 s40, s40, 7
  s_lshl_b32 s41, s40, 7
  s_add_u32 s50, s46, s41
  s_mul_i32 s41, s40, s54
  s_add_u32 s51, s47, s41
  s_add_u32 m0, s48, 32768
  s_nop 0
  buffer_load_dwordx4 v48, s[4:7], s50 offen offset:0 lds
  buffer_load_dwordx4 v49, s[4:7], s50 offen offset:1024 lds
  buffer_load_dwordx4 v50, s[4:7], s50 offen offset:2048 lds
  buffer_load_dwordx4 v51, s[4:7], s50 offen offset:3072 lds
  s_add_u32 m0, s49, 32768
  s_nop 0
  buffer_load_dwordx4 v52, s[8:11], s51 offen offset:0 lds
  buffer_load_dwordx4 v53, s[8:11], s51 offen offset:1024 lds
  buffer_load_dwordx4 v54, s[8:11], s51 offen offset:2048 lds
  buffer_load_dwordx4 v55, s[8:11], s51 offen offset:3072 lds
  v_and_b32 v2, 15, v1
  v_lshlrev_b32 v3, 3, v2
  s_lshl_b32 s40, s33, 7
  s_add_u32 s40, s40, 157696
  v_add_u32 v3, s40, v3
  ds_read_b64 v[44:45], v3
  s_lshl_b32 s40, s36, 3
  s_add_u32 s40, s40, s35
  s_lshl_b32 s40, s40, 4
  s_add_u32 s40, s40, s34
  s_lshl_b32 s40, s40, 10
  s_add_u32 s40, s40, 262144
  s_lshl_b32 s41, s33, 8
  s_add_u32 s40, s40, s41
  v_lshlrev_b32 v2, 4, v2
  s_waitcnt lgkmcnt(0)
  v_mov_b32 v46, v45
  v_mov_b32 v45, s1
  v_mov_b32 v47, s1
  s_mov_b64 exec, 0xffff
  buffer_store_dwordx4 v[44:47], v2, s[12:15], s40 offen sc1
  s_mov_b64 exec, -1
  v_and_b32 v2, 31, v1
  v_lshlrev_b32 v2, 2, v2
  buffer_load_dword v40, v2, s[28:31], 0 offen sc1
  s_waitcnt vmcnt(18) lgkmcnt(0)
  s_barrier
  v_add_u32 v124, 98304, v110
  ds_read_b128 v[176:179], v124
  v_add_u32 v125, 98304, v111
  ds_read_b128 v[180:183], v125
  v_add_u32 v126, 98304, v112
  ds_read_b128 v[184:187], v126
  v_add_u32 v127, 98304, v113
  ds_read_b128 v[188:191], v127
  s_add_u32 s40, s37, 6
  s_and_b32 s40, s40, 7
  s_lshl_b32 s41, s40, 7
  s_add_u32 s50, s46, s41
  s_mul_i32 s41, s40, s54
  s_add_u32 s51, s47, s41
  s_add_u32 m0, s48, 65536
  s_nop 0
  buffer_load_dwordx4 v48, s[4:7], s50 offen offset:0 lds
  buffer_load_dwordx4 v49, s[4:7], s50 offen offset:1024 lds
  buffer_load_dwordx4 v50, s[4:7], s50 offen offset:2048 lds
  buffer_load_dwordx4 v51, s[4:7], s50 offen offset:3072 lds
  s_add_u32 m0, s49, 65536
  s_nop 0
  buffer_load_dwordx4 v52, s[8:11], s51 offen offset:0 lds
  buffer_load_dwordx4 v53, s[8:11], s51 offen offset:1024 lds
  buffer_load_dwordx4 v54, s[8:11], s51 offen offset:2048 lds
  buffer_load_dwordx4 v55, s[8:11], s51 offen offset:3072 lds
  s_waitcnt vmcnt(18) lgkmcnt(0)
  s_barrier
  v_add_u32 v124, 0, v110
  ds_read_b128 v[192:195], v124
  v_add_u32 v125, 0, v111
  ds_read_b128 v[196:199], v125
  v_add_u32 v126, 0, v112
  ds_read_b128 v[200:203], v126
  v_add_u32 v127, 0, v113
  ds_read_b128 v[204:207], v127
  s_add_u32 s40, s37, 7
  s_and_b32 s40, s40, 7
  s_lshl_b32 s41, s40, 7
  s_add_u32 s50, s46, s41
  s_mul_i32 s41, s40, s54
  s_add_u32 s51, s47, s41
  s_add_u32 m0, s48, 98304
  s_nop 0
  buffer_load_dwordx4 v48, s[4:7], s50 offen offset:0 lds
  buffer_load_dwordx4 v49, s[4:7], s50 offen offset:1024 lds
  buffer_load_dwordx4 v50, s[4:7], s50 offen offset:2048 lds
  buffer_load_dwordx4 v51, s[4:7], s50 offen offset:3072 lds
  s_add_u32 m0, s49, 98304
  s_nop 0
  buffer_load_dwordx4 v52, s[8:11], s51 offen offset:0 lds
  buffer_load_dwordx4 v53, s[8:11], s51 offen offset:1024 lds
  buffer_load_dwordx4 v54, s[8:11], s51 offen offset:2048 lds
  buffer_load_dwordx4 v55, s[8:11], s51 offen offset:3072 lds
  s_waitcnt vmcnt(18) lgkmcnt(0)
  s_barrier
  v_add_u32 v124, 32768, v110
  ds_read_b128 v[208:211], v124
  v_add_u32 v125, 32768, v111
  ds_read_b128 v[212:215], v125
  v_add_u32 v126, 32768, v112
  ds_read_b128 v[216:219], v126
  v_add_u32 v127, 32768, v113
  ds_read_b128 v[220:223], v127
  s_add_u32 s40, s37, 0
  s_and_b32 s40, s40, 7
  s_mul_i32 s41, s40, s54
  s_add_u32 s51, s52, s41
  s_add_u32 m0, s53, 0
  s_nop 0
  buffer_load_dwordx4 v107, s[8:11], s51 offen offset:0 lds
  buffer_load_dwordx4 v108, s[8:11], s51 offen offset:1024 lds
  buffer_load_dwordx4 v109, s[8:11], s51 offen offset:2048 lds
  s_waitcnt vmcnt(11) lgkmcnt(0)
  s_barrier
  v_add_u32 v124, 65536, v110
  ds_read_b128 v[224:227], v124
  v_add_u32 v125, 65536, v111
  ds_read_b128 v[228:231], v125
  v_add_u32 v126, 65536, v112
  ds_read_b128 v[232:235], v126
  v_add_u32 v127, 65536, v113
  ds_read_b128 v[236:239], v127
  s_add_u32 s40, s37, 1
  s_and_b32 s40, s40, 7
  s_mul_i32 s41, s40, s54
  s_add_u32 s51, s52, s41
  s_add_u32 m0, s53, 12288
  s_nop 0
  buffer_load_dwordx4 v107, s[8:11], s51 offen offset:0 lds
  buffer_load_dwordx4 v108, s[8:11], s51 offen offset:1024 lds
  buffer_load_dwordx4 v109, s[8:11], s51 offen offset:2048 lds
  s_add_u32 s40, s37, 2
  s_and_b32 s40, s40, 7
  s_mul_i32 s41, s40, s54
  s_add_u32 s51, s52, s41
  s_add_u32 m0, s53, 24576
  s_nop 0
  buffer_load_dwordx4 v107, s[8:11], s51 offen offset:0 lds
  buffer_load_dwordx4 v108, s[8:11], s51 offen offset:1024 lds
  buffer_load_dwordx4 v109, s[8:11], s51 offen offset:2048 lds
  buffer_load_dwordx4 v[36:39], v16, s[12:15], 0 offen sc1
  buffer_load_dwordx2 v[20:21], v17, s[12:15], 0 offen offset:0 sc1
  buffer_load_dwordx2 v[22:23], v17, s[12:15], 0 offen offset:1024 sc1
  buffer_load_dwordx2 v[24:25], v17, s[12:15], 0 offen offset:2048 sc1
  buffer_load_dwordx2 v[26:27], v17, s[12:15], 0 offen offset:3072 sc1
  buffer_load_dwordx2 v[28:29], v17, s[12:15], s56 offen offset:0 sc1
  buffer_load_dwordx2 v[30:31], v17, s[12:15], s56 offen offset:1024 sc1
  buffer_load_dwordx2 v[32:33], v17, s[12:15], s56 offen offset:2048 sc1
  buffer_load_dwordx2 v[34:35], v17, s[12:15], s56 offen offset:3072 sc1
  s_waitcnt vmcnt(18) lgkmcnt(0)
  s_barrier
  v_add_u32 v124, 98304, v110
  ds_read_b128 v[240:243], v124
  v_add_u32 v125, 98304, v111
  ds_read_b128 v[244:247], v125
  v_add_u32 v126, 98304, v112
  ds_read_b128 v[248:251], v126
  v_add_u32 v127, 98304, v113
  ds_read_b128 v[252:255], v127
  s_add_u32 s40, s37, 3
  s_and_b32 s40, s40, 7
  s_mul_i32 s41, s40, s54
  s_add_u32 s51, s52, s41
  s_add_u32 m0, s53, 36864
  s_nop 0
  buffer_load_dwordx4 v107, s[8:11], s51 offen offset:0 lds
  buffer_load_dwordx4 v108, s[8:11], s51 offen offset:1024 lds
  buffer_load_dwordx4 v109, s[8:11], s51 offen offset:2048 lds
  s_waitcnt vmcnt(3)
  s_mov_b32 s3, 0
L_tg_1:
  v_xor_b32 v2, s1, v38
  v_xor_b32 v3, s1, v21
  v_or_b32 v2, v2, v3
  v_xor_b32 v3, s1, v23
  v_or_b32 v2, v2, v3
  v_xor_b32 v3, s1, v25
  v_or_b32 v2, v2, v3
  v_xor_b32 v3, s1, v27
  v_or_b32 v2, v2, v3
  v_xor_b32 v3, s1, v29
  v_or_b32 v2, v2, v3
  v_xor_b32 v3, s1, v31
  v_or_b32 v2, v2, v3
  v_xor_b32 v3, s1, v33
  v_or_b32 v2, v2, v3
  v_xor_b32 v3, s1, v35
  v_or_b32 v2, v2, v3
  v_cmp_ne_u32 vcc, 0, v2
  s_nop 0
  s_cbranch_vccz L_tg_1x
  s_add_u32 s3, s3, 1
  s_cmp_gt_u32 s3, 20000
  s_cbranch_scc1 L_tg_1x
  buffer_load_dwordx4 v[36:39], v16, s[12:15], 0 offen sc1
  buffer_load_dwordx2 v[20:21], v17, s[12:15], 0 offen offset:0 sc1
  buffer_load_dwordx2 v[22:23], v17, s[12:15], 0 offen offset:1024 sc1
  buffer_load_dwordx2 v[24:25], v17, s[12:15], 0 offen offset:2048 sc1
  buffer_load_dwordx2 v[26:27], v17, s[12:15], 0 offen offset:3072 sc1
  buffer_load_dwordx2 v[28:29], v17, s[12:15], s56 offen offset:0 sc1
  buffer_load_dwordx2 v[30:31], v17, s[12:15], s56 offen offset:1024 sc1
  buffer_load_dwordx2 v[32:33], v17, s[12:15], s56 offen offset:2048 sc1
  buffer_load_dwordx2 v[34:35], v17, s[12:15], s56 offen offset:3072 sc1
  s_waitcnt vmcnt(0)
  s_branch L_tg_1
L_tg_1x:
  v_and_b32 v2, 31, v1
  v_lshlrev_b32 v2, 2, v2
  v_cmp_ne_u32 vcc, 1, v40
  s_nop 0
  s_cbranch_vccz L_pc_2x
  s_mov_b32 s3, 0
L_pc_2:
  s_add_u32 s3, s3, 1
  s_cmp_gt_u32 s3, 20000
  s_cbranch_scc1 L_pc_2x
  buffer_load_dword v40, v2, s[28:31], 0 offen sc1
  s_waitcnt vmcnt(0)
  v_cmp_ne_u32 vcc, 1, v40
  s_nop 0
  s_cbranch_vccnz L_pc_2
L_pc_2x:
  s_lshl_b32 s40, s33, 7
  s_add_u32 s40, s40, 155648
  v_add_u32 v3, s40, v2
  ds_write_b32 v3, v36
  ds_write_b32 v3, v37 offset:512
  v_add_f32 v20, v20, v28
  v_add_f32 v22, v22, v30
  v_add_f32 v24, v24, v32
  v_add_f32 v26, v26, v34
  v_add_f32 v20, v20, v24
  v_add_f32 v22, v22, v26
  v_add_f32 v20, v20, v22
  v_mov_b32 v4, v20
  s_nop 1
  v_permlane32_swap_b32 v4, v20
  v_add_f32 v20, v20, v4
  s_lshl_b32 s40, s33, 7
  s_add_u32 s40, s40, 156672
  v_add_u32 v3, s40, v2
  ds_write_b32 v3, v20
L_Bpb0:
  s_waitcnt vmcnt(15) lgkmcnt(0)
  s_barrier
  v_add_u32 v124, 0, v114
  v_add_u32 v125, 0, v115
  v_add_u32 v126, 0, v116
  ds_read_b64_tr_b16 v[64:65], v124 offset:0
  ds_read_b64_tr_b16 v[66:67], v124 offset:768
  ds_read_b64_tr_b16 v[68:69], v125 offset:0
  ds_read_b64_tr_b16 v[70:71], v125 offset:768
  ds_read_b64_tr_b16 v[72:73], v126 offset:0
  ds_read_b64_tr_b16 v[74:75], v126 offset:768
  ds_read_b64_tr_b16 v[76:77], v124 offset:3072
  ds_read_b64_tr_b16 v[78:79], v124 offset:3840
  ds_read_b64_tr_b16 v[80:81], v125 offset:3072
  ds_read_b64_tr_b16 v[82:83], v125 offset:3840
  ds_read_b64_tr_b16 v[84:85], v126 offset:3072
  ds_read_b64_tr_b16 v[86:87], v126 offset:3840
  s_waitcnt lgkmcnt(6)
  v_mfma_f32_32x32x16_bf16 v[16:31], v[64:67], v[128:131], 0
  s_add_u32 s40, s37, 4
  s_and_b32 s40, s40, 7
  s_mul_i32 s41, s40, s54
  s_add_u32 s51, s52, s41
  s_add_u32 m0, s53, 49152
  s_nop 0
  buffer_load_dwordx4 v107, s[8:11], s51 offen offset:0 lds
  buffer_load_dwordx4 v108, s[8:11], s51 offen offset:1024 lds
  buffer_load_dwordx4 v109, s[8:11], s51 offen offset:2048 lds
  ds_read_b64_tr_b16 v[88:89], v124 offset:6144
  ds_read_b64_tr_b16 v[90:91], v124 offset:6912
  v_mfma_f32_32x32x16_bf16 v[32:47], v[68:71], v[128:131], 0
  ds_read_b64_tr_b16 v[92:93], v125 offset:6144
  ds_read_b64_tr_b16 v[94:95], v125 offset:6912
  v_mfma_f32_32x32x16_bf16 v[48:63], v[72:75], v[128:131], 0
  ds_read_b64_tr_b16 v[96:97], v126 offset:6144
  ds_read_b64_tr_b16 v[98:99], v126 offset:6912
  v_mfma_f32_16x16x32_bf16 v[100:103], v[64:67], v[118:121], 0
  s_waitcnt lgkmcnt(6)
  v_mfma_f32_32x32x16_bf16 v[16:31], v[76:79], v[132:135], v[16:31]
  s_add_u32 s40, s37, 5
  s_and_b32 s40, s40, 7
  s_mul_i32 s41, s40, s54
  s_add_u32 s51, s52, s41
  s_add_u32 m0, s53, 61440
  s_nop 0
  buffer_load_dwordx4 v107, s[8:11], s51 offen offset:0 lds
  buffer_load_dwordx4 v108, s[8:11], s51 offen offset:1024 lds
  buffer_load_dwordx4 v109, s[8:11], s51 offen offset:2048 lds
  ds_read_b64_tr_b16 v[64:65], v124 offset:9216
  ds_read_b64_tr_b16 v[66:67], v124 offset:9984
  v_mfma_f32_32x32x16_bf16 v[32:47], v[80:83], v[132:135], v[32:47]
  ds_read_b64_tr_b16 v[68:69], v125 offset:9216
  ds_read_b64_tr_b16 v[70:71], v125 offset:9984
  v_mfma_f32_32x32x16_bf16 v[48:63], v[84:87], v[132:135], v[48:63]
  ds_read_b64_tr_b16 v[72:73], v126 offset:9216
  ds_read_b64_tr_b16 v[74:75], v126 offset:9984
  v_mfma_f32_16x16x32_bf16 v[100:103], v[76:79], v[118:121], v[100:103]
  s_waitcnt lgkmcnt(6)
  v_mfma_f32_32x32x16_bf16 v[16:31], v[88:91], v[136:139], v[16:31]
  s_add_u32 s40, s37, 6
  s_and_b32 s40, s40, 7
  s_mul_i32 s41, s40, s54
  s_add_u32 s51, s52, s41
  s_add_u32 m0, s53, 73728
  s_nop 0
  buffer_load_dwordx4 v107, s[8:11], s51 offen offset:0 lds
  buffer_load_dwordx4 v108, s[8:11], s51 offen offset:1024 lds
  buffer_load_dwordx4 v109, s[8:11], s51 offen offset:2048 lds
  ds_read_b64_tr_b16 v[76:77], v124 offset:12288
  ds_read_b64_tr_b16 v[78:79], v124 offset:13056
  v_mfma_f32_32x32x16_bf16 v[32:47], v[92:95], v[136:139], v[32:47]
  ds_read_b64_tr_b16 v[80:81], v125 offset:12288
  ds_read_b64_tr_b16 v[82:83], v125 offset:13056
  v_mfma_f32_32x32x16_bf16 v[48:63], v[96:99], v[136:139], v[48:63]
  ds_read_b64_tr_b16 v[84:85], v126 offset:12288
  ds_read_b64_tr_b16 v[86:87], v126 offset:13056
  v_mfma_f32_16x16x32_bf16 v[100:103], v[88:91], v[118:121], v[100:103]
  s_waitcnt lgkmcnt(6)
  v_mfma_f32_32x32x16_bf16 v[16:31], v[64:67], v[140:143], v[16:31]
  s_add_u32 s40, s37, 7
  s_and_b32 s40, s40, 7
  s_mul_i32 s41, s40, s54
  s_add_u32 s51, s52, s41
  s_add_u32 m0, s53, 86016
  s_nop 0
  buffer_load_dwordx4 v107, s[8:11], s51 offen offset:0 lds
  buffer_load_dwordx4 v108, s[8:11], s51 offen offset:1024 lds
  buffer_load_dwordx4 v109, s[8:11], s51 offen offset:2048 lds
  ds_read_b64_tr_b16 v[88:89], v124 offset:15360
  ds_read_b64_tr_b16 v[90:91], v124 offset:16128
  v_mfma_f32_32x32x16_bf16 v[32:47], v[68:71], v[140:143], v[32:47]
  ds_read_b64_tr_b16 v[92:93], v125 offset:15360
  ds_read_b64_tr_b16 v[94:95], v125 offset:16128
  v_mfma_f32_32x32x16_bf16 v[48:63], v[72:75], v[140:143], v[48:63]
  ds_read_b64_tr_b16 v[96:97], v126 offset:15360
  ds_read_b64_tr_b16 v[98:99], v126 offset:16128
  v_mfma_f32_16x16x32_bf16 v[100:103], v[64:67], v[118:121], v[100:103]
  s_waitcnt lgkmcnt(6)
  v_mfma_f32_32x32x16_bf16 v[16:31], v[76:79], v[144:147], v[16:31]
  s_waitcnt vmcnt(12)
  v_mov_b32 v2, 157672
  v_mov_b32 v3, 1
  s_mov_b64 exec, 1
  ds_add_u32 v2, v3
  s_mov_b64 exec, -1
  ds_read_b64_tr_b16 v[64:65], v124 offset:18432
  ds_read_b64_tr_b16 v[66:67], v124 offset:19200
  v_mfma_f32_32x32x16_bf16 v[32:47], v[80:83], v[144:147], v[32:47]
  ds_read_b64_tr_b16 v[68:69], v125 offset:18432
  ds_read_b64_tr_b16 v[70:71], v125 offset:19200
  v_mfma_f32_32x32x16_bf16 v[48:63], v[84:87], v[144:147], v[48:63]
  ds_read_b64_tr_b16 v[72:73], v126 offset:18432
  ds_read_b64_tr_b16 v[74:75], v126 offset:19200
  v_mfma_f32_16x16x32_bf16 v[100:103], v[76:79], v[118:121], v[100:103]
  s_waitcnt lgkmcnt(6)
  v_mfma_f32_32x32x16_bf16 v[16:31], v[88:91], v[148:151], v[16:31]
  ds_read_b64_tr_b16 v[76:77], v124 offset:21504
  ds_read_b64_tr_b16 v[78:79], v124 offset:22272
  v_mfma_f32_32x32x16_bf16 v[32:47], v[92:95], v[148:151], v[32:47]
  ds_read_b64_tr_b16 v[80:81], v125 offset:21504
  ds_read_b64_tr_b16 v[82:83], v125 offset:22272
  v_mfma_f32_32x32x16_bf16 v[48:63], v[96:99], v[148:151], v[48:63]
  ds_read_b64_tr_b16 v[84:85], v126 offset:21504
  ds_read_b64_tr_b16 v[86:87], v126 offset:22272
  v_mfma_f32_16x16x32_bf16 v[100:103], v[88:91], v[118:121], v[100:103]
  s_waitcnt lgkmcnt(6)
  v_mfma_f32_32x32x16_bf16 v[16:31], v[64:67], v[152:155], v[16:31]
  v_mov_b32 v2, 157672
  s_mov_b32 s3, 0
L_cw_3:
  ds_read_b32 v3, v2
  s_waitcnt lgkmcnt(0)
  v_readfirstlane_b32 s43, v3
  s_nop 0
  s_cmp_ge_u32 s43, 4
  s_cbranch_scc1 L_cw_3x
  s_sleep 1
  s_add_u32 s3, s3, 1
  s_cmp_gt_u32 s3, 160000
  s_cbranch_scc0 L_cw_3
L_cw_3x:
  ds_read_b64_tr_b16 v[88:89], v124 offset:24576
  ds_read_b64_tr_b16 v[90:91], v124 offset:25344
  v_mfma_f32_32x32x16_bf16 v[32:47], v[68:71], v[152:155], v[32:47]
  ds_read_b64_tr_b16 v[92:93], v125 offset:24576
  ds_read_b64_tr_b16 v[94:95], v125 offset:25344
  v_mfma_f32_32x32x16_bf16 v[48:63], v[72:75], v[152:155], v[48:63]
  ds_read_b64_tr_b16 v[96:97], v126 offset:24576
  ds_read_b64_tr_b16 v[98:99], v126 offset:25344
  v_mfma_f32_16x16x32_bf16 v[100:103], v[64:67], v[118:121], v[100:103]
  s_waitcnt lgkmcnt(6)
  v_mfma_f32_32x32x16_bf16 v[16:31], v[76:79], v[156:159], v[16:31]
  ds_read_b64_tr_b16 v[64:65], v124 offset:27648
  ds_read_b64_tr_b16 v[66:67], v124 offset:28416
  v_mfma_f32_32x32x16_bf16 v[32:47], v[80:83], v[156:159], v[32:47]
  ds_read_b64_tr_b16 v[68:69], v125 offset:27648
  ds_read_b64_tr_b16 v[70:71], v125 offset:28416
  v_mfma_f32_32x32x16_bf16 v[48:63], v[84:87], v[156:159], v[48:63]
  ds_read_b64_tr_b16 v[72:73], v126 offset:27648
  ds_read_b64_tr_b16 v[74:75], v126 offset:28416
  v_mfma_f32_16x16x32_bf16 v[100:103], v[76:79], v[118:121], v[100:103]
  s_waitcnt lgkmcnt(6)
  v_mfma_f32_32x32x16_bf16 v[16:31], v[88:91], v[160:163], v[16:31]
  ds_read_b64_tr_b16 v[76:77], v124 offset:30720
  ds_read_b64_tr_b16 v[78:79], v124 offset:31488
  v_mfma_f32_32x32x16_bf16 v[32:47], v[92:95], v[160:163], v[32:47]
  ds_read_b64_tr_b16 v[80:81], v125 offset:30720
  ds_read_b64_tr_b16 v[82:83], v125 offset:31488
  v_mfma_f32_32x32x16_bf16 v[48:63], v[96:99], v[160:163], v[48:63]
  ds_read_b64_tr_b16 v[84:85], v126 offset:30720
  ds_read_b64_tr_b16 v[86:87], v126 offset:31488
  v_mfma_f32_16x16x32_bf16 v[100:103], v[88:91], v[118:121], v[100:103]
  s_waitcnt lgkmcnt(6)
  v_mfma_f32_32x32x16_bf16 v[16:31], v[64:67], v[164:167], v[16:31]
  v_add_u32 v124, 32768, v114
  v_add_u32 v125, 32768, v115
  v_add_u32 v126, 32768, v116
  ds_read_b64_tr_b16 v[88:89], v124 offset:1024
  ds_read_b64_tr_b16 v[90:91], v124 offset:1792
  v_mfma_f32_32x32x16_bf16 v[32:47], v[68:71], v[164:167], v[32:47]
  ds_read_b64_tr_b16 v[92:93], v125 offset:1024
  ds_read_b64_tr_b16 v[94:95], v125 offset:1792
  v_mfma_f32_32x32x16_bf16 v[48:63], v[72:75], v[164:167], v[48:63]
  ds_read_b64_tr_b16 v[96:97], v126 offset:1024
  ds_read_b64_tr_b16 v[98:99], v126 offset:1792
  v_mfma_f32_16x16x32_bf16 v[100:103], v[64:67], v[118:121], v[100:103]
  s_waitcnt lgkmcnt(6)
  v_mfma_f32_32x32x16_bf16 v[16:31], v[76:79], v[168:171], v[16:31]
  ds_read_b64_tr_b16 v[64:65], v124 offset:4096
  ds_read_b64_tr_b16 v[66:67], v124 offset:4864
  v_mfma_f32_32x32x16_bf16 v[32:47], v[80:83], v[168:171], v[32:47]
  ds_read_b64_tr_b16 v[68:69], v125 offset:4096
  ds_read_b64_tr_b16 v[70:71], v125 offset:4864
  v_mfma_f32_32x32x16_bf16 v[48:63], v[84:87], v[168:171], v[48:63]
  ds_read_b64_tr_b16 v[72:73], v126 offset:4096
  ds_read_b64_tr_b16 v[74:75], v126 offset:4864
  v_mfma_f32_16x16x32_bf16 v[100:103], v[76:79], v[118:121], v[100:103]
  s_waitcnt lgkmcnt(6)
  v_mfma_f32_32x32x16_bf16 v[16:31], v[88:91], v[172:175], v[16:31]
  ds_read_b64_tr_b16 v[76:77], v124 offset:7168
  ds_read_b64_tr_b16 v[78:79], v124 offset:7936
  v_mfma_f32_32x32x16_bf16 v[32:47], v[92:95], v[172:175], v[32:47]
  ds_read_b64_tr_b16 v[80:81], v125 offset:7168
  ds_read_b64_tr_b16 v[82:83], v125 offset:7936
  v_mfma_f32_32x32x16_bf16 v[48:63], v[96:99], v[172:175], v[48:63]
  ds_read_b64_tr_b16 v[84:85], v126 offset:7168
  ds_read_b64_tr_b16 v[86:87], v126 offset:7936
  v_mfma_f32_16x16x32_bf16 v[100:103], v[88:91], v[118:121], v[100:103]
  s_waitcnt lgkmcnt(6)
  v_mfma_f32_32x32x16_bf16 v[16:31], v[64:67], v[176:179], v[16:31]
  s_waitcnt vmcnt(0)
  v_mov_b32 v2, 157676
  v_mov_b32 v3, 1
  s_mov_b64 exec, 1
  ds_add_u32 v2, v3
  s_mov_b64 exec, -1
  ds_read_b64_tr_b16 v[88:89], v124 offset:10240
  ds_read_b64_tr_b16 v[90:91], v124 offset:11008
  v_mfma_f32_32x32x16_bf16 v[32:47], v[68:71], v[176:179], v[32:47]
  ds_read_b64_tr_b16 v[92:93], v125 offset:10240
  ds_read_b64_tr_b16 v[94:95], v125 offset:11008
  v_mfma_f32_32x32x16_bf16 v[48:63], v[72:75], v[176:179], v[48:63]
  ds_read_b64_tr_b16 v[96:97], v126 offset:10240
  ds_read_b64_tr_b16 v[98:99], v126 offset:11008
  v_mfma_f32_16x16x32_bf16 v[100:103], v[64:67], v[118:121], v[100:103]
  s_waitcnt lgkmcnt(6)
  v_mfma_f32_32x32x16_bf16 v[16:31], v[76:79], v[180:183], v[16:31]
  ds_read_b64_tr_b16 v[64:65], v124 offset:13312
  ds_read_b64_tr_b16 v[66:67], v124 offset:14080
  v_mfma_f32_32x32x16_bf16 v[32:47], v[80:83], v[180:183], v[32:47]
  ds_read_b64_tr_b16 v[68:69], v125 offset:13312
  ds_read_b64_tr_b16 v[70:71], v125 offset:14080
  v_mfma_f32_32x32x16_bf16 v[48:63], v[84:87], v[180:183], v[48:63]
  ds_read_b64_tr_b16 v[72:73], v126 offset:13312
  ds_read_b64_tr_b16 v[74:75], v126 offset:14080
  v_mfma_f32_16x16x32_bf16 v[100:103], v[76:79], v[118:121], v[100:103]
  s_waitcnt lgkmcnt(6)
  v_mfma_f32_32x32x16_bf16 v[16:31], v[88:91], v[184:187], v[16:31]
  v_mov_b32 v2, 157676
  s_mov_b32 s3, 0
L_cw_4:
  ds_read_b32 v3, v2
  s_waitcnt lgkmcnt(0)
  v_readfirstlane_b32 s43, v3
  s_nop 0
  s_cmp_ge_u32 s43, 4
  s_cbranch_scc1 L_cw_4x
  s_sleep 1
  s_add_u32 s3, s3, 1
  s_cmp_gt_u32 s3, 160000
  s_cbranch_scc0 L_cw_4
L_cw_4x:
  ds_read_b64_tr_b16 v[76:77], v124 offset:16384
  ds_read_b64_tr_b16 v[78:79], v124 offset:17152
  v_mfma_f32_32x32x16_bf16 v[32:47], v[92:95], v[184:187], v[32:47]
  ds_read_b64_tr_b16 v[80:81], v125 offset:16384
  ds_read_b64_tr_b16 v[82:83], v125 offset:17152
  v_mfma_f32_32x32x16_bf16 v[48:63], v[96:99], v[184:187], v[48:63]
  ds_read_b64_tr_b16 v[84:85], v126 offset:16384
  ds_read_b64_tr_b16 v[86:87], v126 offset:17152
  v_mfma_f32_16x16x32_bf16 v[100:103], v[88:91], v[118:121], v[100:103]
  s_waitcnt lgkmcnt(6)
  v_mfma_f32_32x32x16_bf16 v[16:31], v[64:67], v[188:191], v[16:31]
  ds_read_b64_tr_b16 v[88:89], v124 offset:19456
  ds_read_b64_tr_b16 v[90:91], v124 offset:20224
  v_mfma_f32_32x32x16_bf16 v[32:47], v[68:71], v[188:191], v[32:47]
  ds_read_b64_tr_b16 v[92:93], v125 offset:19456
  ds_read_b64_tr_b16 v[94:95], v125 offset:20224
  v_mfma_f32_32x32x16_bf16 v[48:63], v[72:75], v[188:191], v[48:63]
  ds_read_b64_tr_b16 v[96:97], v126 offset:19456
  ds_read_b64_tr_b16 v[98:99], v126 offset:20224
  v_mfma_f32_16x16x32_bf16 v[100:103], v[64:67], v[118:121], v[100:103]
  s_waitcnt lgkmcnt(6)
  v_mfma_f32_32x32x16_bf16 v[16:31], v[76:79], v[192:195], v[16:31]
  ds_read_b64_tr_b16 v[64:65], v124 offset:22528
  ds_read_b64_tr_b16 v[66:67], v124 offset:23296
  v_mfma_f32_32x32x16_bf16 v[32:47], v[80:83], v[192:195], v[32:47]
  ds_read_b64_tr_b16 v[68:69], v125 offset:22528
  ds_read_b64_tr_b16 v[70:71], v125 offset:23296
  v_mfma_f32_32x32x16_bf16 v[48:63], v[84:87], v[192:195], v[48:63]
  ds_read_b64_tr_b16 v[72:73], v126 offset:22528
  ds_read_b64_tr_b16 v[74:75], v126 offset:23296
  v_mfma_f32_16x16x32_bf16 v[100:103], v[76:79], v[118:121], v[100:103]
  s_waitcnt lgkmcnt(6)
  v_mfma_f32_32x32x16_bf16 v[16:31], v[88:91], v[196:199], v[16:31]
  ds_read_b64_tr_b16 v[76:77], v124 offset:25600
  ds_read_b64_tr_b16 v[78:79], v124 offset:26368
  v_mfma_f32_32x32x16_bf16 v[32:47], v[92:95], v[196:199], v[32:47]
  ds_read_b64_tr_b16 v[80:81], v125 offset:25600
  ds_read_b64_tr_b16 v[82:83], v125 offset:26368
  v_mfma_f32_32x32x16_bf16 v[48:63], v[96:99], v[196:199], v[48:63]
  ds_read_b64_tr_b16 v[84:85], v126 offset:25600
  ds_read_b64_tr_b16 v[86:87], v126 offset:26368
  v_mfma_f32_16x16x32_bf16 v[100:103], v[88:91], v[118:121], v[100:103]
  s_waitcnt lgkmcnt(6)
  v_mfma_f32_32x32x16_bf16 v[16:31], v[64:67], v[200:203], v[16:31]
  ds_read_b64_tr_b16 v[88:89], v124 offset:28672
  ds_read_b64_tr_b16 v[90:91], v124 offset:29440
  v_mfma_f32_32x32x16_bf16 v[32:47], v[68:71], v[200:203], v[32:47]
  ds_read_b64_tr_b16 v[92:93], v125 offset:28672
  ds_read_b64_tr_b16 v[94:95], v125 offset:29440
  v_mfma_f32_32x32x16_bf16 v[48:63], v[72:75], v[200:203], v[48:63]
  ds_read_b64_tr_b16 v[96:97], v126 offset:28672
  ds_read_b64_tr_b16 v[98:99], v126 offset:29440
  v_mfma_f32_16x16x32_bf16 v[100:103], v[64:67], v[118:121], v[100:103]
  s_waitcnt lgkmcnt(6)
  v_mfma_f32_32x32x16_bf16 v[16:31], v[76:79], v[204:207], v[16:31]
  ds_read_b64_tr_b16 v[64:65], v124 offset:31744
  ds_read_b64_tr_b16 v[66:67], v124 offset:32512
  v_mfma_f32_32x32x16_bf16 v[32:47], v[80:83], v[204:207], v[32:47]
  ds_read_b64_tr_b16 v[68:69], v125 offset:31744
  ds_read_b64_tr_b16 v[70:71], v125 offset:32512
  v_mfma_f32_32x32x16_bf16 v[48:63], v[84:87], v[204:207], v[48:63]
  ds_read_b64_tr_b16 v[72:73], v126 offset:31744
  ds_read_b64_tr_b16 v[74:75], v126 offset:32512
  v_mfma_f32_16x16x32_bf16 v[100:103], v[76:79], v[118:121], v[100:103]
  s_waitcnt lgkmcnt(6)
  v_mfma_f32_32x32x16_bf16 v[16:31], v[88:91], v[208:211], v[16:31]
  v_add_u32 v124, 65536, v114
  v_add_u32 v125, 65536, v115
  v_add_u32 v126, 65536, v116
  ds_read_b64_tr_b16 v[76:77], v124 offset:2048
  ds_read_b64_tr_b16 v[78:79], v124 offset:2816
  v_mfma_f32_32x32x16_bf16 v[32:47], v[92:95], v[208:211], v[32:47]
  ds_read_b64_tr_b16 v[80:81], v125 offset:2048
  ds_read_b64_tr_b16 v[82:83], v125 offset:2816
  v_mfma_f32_32x32x16_bf16 v[48:63], v[96:99], v[208:211], v[48:63]
  ds_read_b64_tr_b16 v[84:85], v126 offset:2048
  ds_read_b64_tr_b16 v[86:87], v126 offset:2816
  v_mfma_f32_16x16x32_bf16 v[100:103], v[88:91], v[118:121], v[100:103]
  s_waitcnt lgkmcnt(6)
  v_mfma_f32_32x32x16_bf16 v[16:31], v[64:67], v[212:215], v[16:31]
  ds_read_b64_tr_b16 v[88:89], v124 offset:5120
  ds_read_b64_tr_b16 v[90:91], v124 offset:5888
  v_mfma_f32_32x32x16_bf16 v[32:47], v[68:71], v[212:215], v[32:47]
  ds_read_b64_tr_b16 v[92:93], v125 offset:5120
  ds_read_b64_tr_b16 v[94:95], v125 offset:5888
  v_mfma_f32_32x32x16_bf16 v[48:63], v[72:75], v[212:215], v[48:63]
  ds_read_b64_tr_b16 v[96:97], v126 offset:5120
  ds_read_b64_tr_b16 v[98:99], v126 offset:5888
  v_mfma_f32_16x16x32_bf16 v[100:103], v[64:67], v[118:121], v[100:103]
  s_waitcnt lgkmcnt(6)
  v_mfma_f32_32x32x16_bf16 v[16:31], v[76:79], v[216:219], v[16:31]
  ds_read_b64_tr_b16 v[64:65], v124 offset:8192
  ds_read_b64_tr_b16 v[66:67], v124 offset:8960
  v_mfma_f32_32x32x16_bf16 v[32:47], v[80:83], v[216:219], v[32:47]
  ds_read_b64_tr_b16 v[68:69], v125 offset:8192
  ds_read_b64_tr_b16 v[70:71], v125 offset:8960
  v_mfma_f32_32x32x16_bf16 v[48:63], v[84:87], v[216:219], v[48:63]
  ds_read_b64_tr_b16 v[72:73], v126 offset:8192
  ds_read_b64_tr_b16 v[74:75], v126 offset:8960
  v_mfma_f32_16x16x32_bf16 v[100:103], v[76:79], v[118:121], v[100:103]
  s_waitcnt lgkmcnt(6)
  v_mfma_f32_32x32x16_bf16 v[16:31], v[88:91], v[220:223], v[16:31]
  ds_read_b64_tr_b16 v[76:77], v124 offset:11264
  ds_read_b64_tr_b16 v[78:79], v124 offset:12032
  v_mfma_f32_32x32x16_bf16 v[32:47], v[92:95], v[220:223], v[32:47]
  ds_read_b64_tr_b16 v[80:81], v125 offset:11264
  ds_read_b64_tr_b16 v[82:83], v125 offset:12032
  v_mfma_f32_32x32x16_bf16 v[48:63], v[96:99], v[220:223], v[48:63]
  ds_read_b64_tr_b16 v[84:85], v126 offset:11264
  ds_read_b64_tr_b16 v[86:87], v126 offset:12032
  v_mfma_f32_16x16x32_bf16 v[100:103], v[88:91], v[118:121], v[100:103]
  s_waitcnt lgkmcnt(6)
  v_mfma_f32_32x32x16_bf16 v[16:31], v[64:67], v[224:227], v[16:31]
  ds_read_b64_tr_b16 v[88:89], v124 offset:14336
  ds_read_b64_tr_b16 v[90:91], v124 offset:15104
  v_mfma_f32_32x32x16_bf16 v[32:47], v[68:71], v[224:227], v[32:47]
  ds_read_b64_tr_b16 v[92:93], v125 offset:14336
  ds_read_b64_tr_b16 v[94:95], v125 offset:15104
  v_mfma_f32_32x32x16_bf16 v[48:63], v[72:75], v[224:227], v[48:63]
  ds_read_b64_tr_b16 v[96:97], v126 offset:14336
  ds_read_b64_tr_b16 v[98:99], v126 offset:15104
  v_mfma_f32_16x16x32_bf16 v[100:103], v[64:67], v[118:121], v[100:103]
  s_waitcnt lgkmcnt(6)
  v_mfma_f32_32x32x16_bf16 v[16:31], v[76:79], v[228:231], v[16:31]
  ds_read_b64_tr_b16 v[64:65], v124 offset:17408
  ds_read_b64_tr_b16 v[66:67], v124 offset:18176
  v_mfma_f32_32x32x16_bf16 v[32:47], v[80:83], v[228:231], v[32:47]
  ds_read_b64_tr_b16 v[68:69], v125 offset:17408
  ds_read_b64_tr_b16 v[70:71], v125 offset:18176
  v_mfma_f32_32x32x16_bf16 v[48:63], v[84:87], v[228:231], v[48:63]
  ds_read_b64_tr_b16 v[72:73], v126 offset:17408
  ds_read_b64_tr_b16 v[74:75], v126 offset:18176
  v_mfma_f32_16x16x32_bf16 v[100:103], v[76:79], v[118:121], v[100:103]
  s_waitcnt lgkmcnt(6)
  v_mfma_f32_32x32x16_bf16 v[16:31], v[88:91], v[232:235], v[16:31]
  ds_read_b64_tr_b16 v[76:77], v124 offset:20480
  ds_read_b64_tr_b16 v[78:79], v124 offset:21248
  v_mfma_f32_32x32x16_bf16 v[32:47], v[92:95], v[232:235], v[32:47]
  ds_read_b64_tr_b16 v[80:81], v125 offset:20480
  ds_read_b64_tr_b16 v[82:83], v125 offset:21248
  v_mfma_f32_32x32x16_bf16 v[48:63], v[96:99], v[232:235], v[48:63]
  ds_read_b64_tr_b16 v[84:85], v126 offset:20480
  ds_read_b64_tr_b16 v[86:87], v126 offset:21248
  v_mfma_f32_16x16x32_bf16 v[100:103], v[88:91], v[118:121], v[100:103]
  s_waitcnt lgkmcnt(6)
  v_mfma_f32_32x32x16_bf16 v[16:31], v[64:67], v[236:239], v[16:31]
  ds_read_b64_tr_b16 v[88:89], v124 offset:23552
  ds_read_b64_tr_b16 v[90:91], v124 offset:24320
  v_mfma_f32_32x32x16_bf16 v[32:47], v[68:71], v[236:239], v[32:47]
  ds_read_b64_tr_b16 v[92:93], v125 offset:23552
  ds_read_b64_tr_b16 v[94:95], v125 offset:24320
  v_mfma_f32_32x32x16_bf16 v[48:63], v[72:75], v[236:239], v[48:63]
  ds_read_b64_tr_b16 v[96:97], v126 offset:23552
  ds_read_b64_tr_b16 v[98:99], v126 offset:24320
  v_mfma_f32_16x16x32_bf16 v[100:103], v[64:67], v[118:121], v[100:103]
  s_waitcnt lgkmcnt(6)
  v_mfma_f32_32x32x16_bf16 v[16:31], v[76:79], v[240:243], v[16:31]
  ds_read_b64_tr_b16 v[64:65], v124 offset:26624
  ds_read_b64_tr_b16 v[66:67], v124 offset:27392
  v_mfma_f32_32x32x16_bf16 v[32:47], v[80:83], v[240:243], v[32:47]
  ds_read_b64_tr_b16 v[68:69], v125 offset:26624
  ds_read_b64_tr_b16 v[70:71], v125 offset:27392
  v_mfma_f32_32x32x16_bf16 v[48:63], v[84:87], v[240:243], v[48:63]
  ds_read_b64_tr_b16 v[72:73], v126 offset:26624
  ds_read_b64_tr_b16 v[74:75], v126 offset:27392
  v_mfma_f32_16x16x32_bf16 v[100:103], v[76:79], v[118:121], v[100:103]
  s_waitcnt lgkmcnt(6)
  v_mfma_f32_32x32x16_bf16 v[16:31], v[88:91], v[244:247], v[16:31]
  ds_read_b64_tr_b16 v[76:77], v124 offset:29696
  ds_read_b64_tr_b16 v[78:79], v124 offset:30464
  v_mfma_f32_32x32x16_bf16 v[32:47], v[92:95], v[244:247], v[32:47]
  ds_read_b64_tr_b16 v[80:81], v125 offset:29696
  ds_read_b64_tr_b16 v[82:83], v125 offset:30464
  v_mfma_f32_32x32x16_bf16 v[48:63], v[96:99], v[244:247], v[48:63]
  ds_read_b64_tr_b16 v[84:85], v126 offset:29696
  ds_read_b64_tr_b16 v[86:87], v126 offset:30464
  v_mfma_f32_16x16x32_bf16 v[100:103], v[88:91], v[118:121], v[100:103]
  s_waitcnt lgkmcnt(6)
  v_mfma_f32_32x32x16_bf16 v[16:31], v[64:67], v[248:251], v[16:31]
  v_mfma_f32_32x32x16_bf16 v[32:47], v[68:71], v[248:251], v[32:47]
  v_mfma_f32_32x32x16_bf16 v[48:63], v[72:75], v[248:251], v[48:63]
  v_mfma_f32_16x16x32_bf16 v[100:103], v[64:67], v[118:121], v[100:103]
  s_waitcnt lgkmcnt(0)
  v_mfma_f32_32x32x16_bf16 v[16:31], v[76:79], v[252:255], v[16:31]
  v_mfma_f32_32x32x16_bf16 v[32:47], v[80:83], v[252:255], v[32:47]
  v_mfma_f32_32x32x16_bf16 v[48:63], v[84:87], v[252:255], v[48:63]
  v_mfma_f32_16x16x32_bf16 v[100:103], v[76:79], v[118:121], v[100:103]
  v_and_b32 v2, 15, v1
  v_lshrrev_b32 v3, 4, v1
  v_cmp_gt_u32 vcc, 2, v2
  v_lshlrev_b32 v2, 6, v2
  v_lshlrev_b32 v3, 4, v3
  v_add_u32 v2, v2, v3
  s_cmp_eq_u32 s33, 3
  s_cselect_b32 s40, 0, s33
  s_lshl_b32 s40, s40, 7
  s_add_u32 s40, s40, 157184
  v_add_u32 v2, s40, v2
  s_and_saveexec_b64 s[60:61], vcc
  ds_write_b128 v2, v[100:103]
  s_mov_b64 exec, s[60:61]
  v_mov_b32 v4, 157688
  v_mov_b32 v5, 1
  s_waitcnt lgkmcnt(0)
  s_mov_b64 exec, 1
  ds_add_u32 v4, v5
  s_mov_b64 exec, -1
  s_mov_b32 s3, 0
L_cnt_5:
  s_add_u32 s3, s3, 1
  s_cmp_gt_u32 s3, 20000
  s_cbranch_scc1 L_cnt_5x
  ds_read_b32 v5, v4
  s_waitcnt lgkmcnt(0)
  v_cmp_gt_u32 vcc, 4, v5
  s_nop 0
  s_cbranch_vccnz L_cnt_5
L_cnt_5x:
  v_and_b32 v2, 31, v1
  v_lshlrev_b32 v2, 2, v2
  s_lshl_b32 s40, s33, 7
  s_add_u32 s40, s40, 155648
  v_add_u32 v2, s40, v2
  ds_read_b32 v122, v2
  ds_read_b32 v123, v2 offset:512
  v_lshrrev_b32 v3, 5, v1
  v_lshlrev_b32 v3, 4, v3
  v_add_u32 v3, 157184, v3
  s_add_u32 s40, s33, 0
  s_cmp_ge_u32 s40, 3
  s_cselect_b32 s41, 3, 0
  s_sub_u32 s40, s40, s41
  s_cmp_ge_u32 s40, 3
  s_cselect_b32 s41, 3, 0
  s_sub_u32 s62, s40, s41
  s_lshl_b32 s40, s62, 7
  v_add_u32 v200, s40, v3
  ds_read_b128 v[128:131], v200 offset:0
  ds_read_b128 v[132:135], v200 offset:32
  ds_read_b128 v[136:139], v200 offset:64
  ds_read_b128 v[140:143], v200 offset:96
  s_add_u32 s40, s33, 1
  s_cmp_ge_u32 s40, 3
  s_cselect_b32 s41, 3, 0
  s_sub_u32 s40, s40, s41
  s_cmp_ge_u32 s40, 3
  s_cselect_b32 s41, 3, 0
  s_sub_u32 s63, s40, s41
  s_lshl_b32 s40, s63, 7
  v_add_u32 v201, s40, v3
  ds_read_b128 v[144:147], v201 offset:0
  ds_read_b128 v[148:151], v201 offset:32
  ds_read_b128 v[152:155], v201 offset:64
  ds_read_b128 v[156:159], v201 offset:96
  s_add_u32 s40, s33, 2
  s_cmp_ge_u32 s40, 3
  s_cselect_b32 s41, 3, 0
  s_sub_u32 s40, s40, s41
  s_cmp_ge_u32 s40, 3
  s_cselect_b32 s41, 3, 0
  s_sub_u32 s64, s40, s41
  s_lshl_b32 s40, s64, 7
  v_add_u32 v202, s40, v3
  ds_read_b128 v[160:163], v202 offset:0
  ds_read_b128 v[164:167], v202 offset:32
  ds_read_b128 v[168:171], v202 offset:64
  ds_read_b128 v[172:175], v202 offset:96
  v_lshlrev_b32 v203, 4, v1
  s_lshl_b32 s42, s34, 2
  s_add_u32 s42, s42, s33
  s_mul_i32 s42, s42, 112
  s_lshr_b32 s43, s59, 4
  s_add_u32 s42, s42, s43
  s_lshl_b32 s55, s42, 10
  s_add_u32 s55, s55, 1048576
  s_waitcnt lgkmcnt(8)
  v_mul_f32 v176, v123, v128
  v_mul_f32 v177, v123, v129
  v_mul_f32 v178, v123, v130
  v_mul_f32 v179, v123, v131
  v_mul_f32 v180, v123, v132
  v_mul_f32 v181, v123, v133
  v_mul_f32 v182, v123, v134
  v_mul_f32 v183, v123, v135
  v_fma_f32 v176, v16, v122, v176
  v_fma_f32 v177, v17, v122, v177
  v_fma_f32 v178, v18, v122, v178
  v_fma_f32 v179, v19, v122, v179
  v_fma_f32 v180, v20, v122, v180
  v_fma_f32 v181, v21, v122, v181
  v_fma_f32 v182, v22, v122, v182
  v_fma_f32 v183, v23, v122, v183
  v_exp_f32 v184, -v176
  v_exp_f32 v185, -v177
  v_exp_f32 v186, -v178
  v_exp_f32 v187, -v179
  v_exp_f32 v188, -v180
  v_exp_f32 v189, -v181
  v_exp_f32 v190, -v182
  v_exp_f32 v191, -v183
  v_add_f32 v184, 1.0, v184
  v_add_f32 v185, 1.0, v185
  v_add_f32 v186, 1.0, v186
  v_add_f32 v187, 1.0, v187
  v_add_f32 v188, 1.0, v188
  v_add_f32 v189, 1.0, v189
  v_add_f32 v190, 1.0, v190
  v_add_f32 v191, 1.0, v191
  v_rcp_f32 v184, v184
  v_rcp_f32 v185, v185
  v_rcp_f32 v186, v186
  v_rcp_f32 v187, v187
  v_rcp_f32 v188, v188
  v_rcp_f32 v189, v189
  v_rcp_f32 v190, v190
  v_rcp_f32 v191, v191
  v_mul_f32 v176, v176, v184
  v_mul_f32 v177, v177, v185
  v_mul_f32 v178, v178, v186
  v_mul_f32 v179, v179, v187
  v_mul_f32 v180, v180, v188
  v_mul_f32 v181, v181, v189
  v_mul_f32 v182, v182, v190
  v_mul_f32 v183, v183, v191
  v_cvt_pk_bf16_f32 v192, v176, v177
  v_cvt_pk_bf16_f32 v193, v178, v179
  v_cvt_pk_bf16_f32 v194, v180, v181
  v_cvt_pk_bf16_f32 v195, v182, v183
  s_lshl_b32 s42, s62, 11
  s_add_u32 s42, s42, s55
  s_add_u32 s42, s42, 0
  buffer_store_dwordx4 v[192:195], v203, s[12:15], s42 offen sc1
  v_mul_f32 v176, v123, v136
  v_mul_f32 v177, v123, v137
  v_mul_f32 v178, v123, v138
  v_mul_f32 v179, v123, v139
  v_mul_f32 v180, v123, v140
  v_mul_f32 v181, v123, v141
  v_mul_f32 v182, v123, v142
  v_mul_f32 v183, v123, v143
  v_fma_f32 v176, v24, v122, v176
  v_fma_f32 v177, v25, v122, v177
  v_fma_f32 v178, v26, v122, v178
  v_fma_f32 v179, v27, v122, v179
  v_fma_f32 v180, v28, v122, v180
  v_fma_f32 v181, v29, v122, v181
  v_fma_f32 v182, v30, v122, v182
  v_fma_f32 v183, v31, v122, v183
  v_exp_f32 v184, -v176
  v_exp_f32 v185, -v177
  v_exp_f32 v186, -v178
  v_exp_f32 v187, -v179
  v_exp_f32 v188, -v180
  v_exp_f32 v189, -v181
  v_exp_f32 v190, -v182
  v_exp_f32 v191, -v183
  v_add_f32 v184, 1.0, v184
  v_add_f32 v185, 1.0, v185
  v_add_f32 v186, 1.0, v186
  v_add_f32 v187, 1.0, v187
  v_add_f32 v188, 1.0, v188
  v_add_f32 v189, 1.0, v189
  v_add_f32 v190, 1.0, v190
  v_add_f32 v191, 1.0, v191
  v_rcp_f32 v184, v184
  v_rcp_f32 v185, v185
  v_rcp_f32 v186, v186
  v_rcp_f32 v187, v187
  v_rcp_f32 v188, v188
  v_rcp_f32 v189, v189
  v_rcp_f32 v190, v190
  v_rcp_f32 v191, v191
  v_mul_f32 v176, v176, v184
  v_mul_f32 v177, v177, v185
  v_mul_f32 v178, v178, v186
  v_mul_f32 v179, v179, v187
  v_mul_f32 v180, v180, v188
  v_mul_f32 v181, v181, v189
  v_mul_f32 v182, v182, v190
  v_mul_f32 v183, v183, v191
  v_cvt_pk_bf16_f32 v196, v176, v177
  v_cvt_pk_bf16_f32 v197, v178, v179
  v_cvt_pk_bf16_f32 v198, v180, v181
  v_cvt_pk_bf16_f32 v199, v182, v183
  s_lshl_b32 s42, s62, 11
  s_add_u32 s42, s42, s55
  s_add_u32 s42, s42, 1024
  buffer_store_dwordx4 v[196:199], v203, s[12:15], s42 offen sc1
  s_waitcnt lgkmcnt(4)
  v_mul_f32 v176, v123, v144
  v_mul_f32 v177, v123, v145
  v_mul_f32 v178, v123, v146
  v_mul_f32 v179, v123, v147
  v_mul_f32 v180, v123, v148
  v_mul_f32 v181, v123, v149
  v_mul_f32 v182, v123, v150
  v_mul_f32 v183, v123, v151
  v_fma_f32 v176, v32, v122, v176
  v_fma_f32 v177, v33, v122, v177
  v_fma_f32 v178, v34, v122, v178
  v_fma_f32 v179, v35, v122, v179
  v_fma_f32 v180, v36, v122, v180
  v_fma_f32 v181, v37, v122, v181
  v_fma_f32 v182, v38, v122, v182
  v_fma_f32 v183, v39, v122, v183
  v_exp_f32 v184, -v176
  v_exp_f32 v185, -v177
  v_exp_f32 v186, -v178
  v_exp_f32 v187, -v179
  v_exp_f32 v188, -v180
  v_exp_f32 v189, -v181
  v_exp_f32 v190, -v182
  v_exp_f32 v191, -v183
  v_add_f32 v184, 1.0, v184
  v_add_f32 v185, 1.0, v185
  v_add_f32 v186, 1.0, v186
  v_add_f32 v187, 1.0, v187
  v_add_f32 v188, 1.0, v188
  v_add_f32 v189, 1.0, v189
  v_add_f32 v190, 1.0, v190
  v_add_f32 v191, 1.0, v191
  v_rcp_f32 v184, v184
  v_rcp_f32 v185, v185
  v_rcp_f32 v186, v186
  v_rcp_f32 v187, v187
  v_rcp_f32 v188, v188
  v_rcp_f32 v189, v189
  v_rcp_f32 v190, v190
  v_rcp_f32 v191, v191
  v_mul_f32 v176, v176, v184
  v_mul_f32 v177, v177, v185
  v_mul_f32 v178, v178, v186
  v_mul_f32 v179, v179, v187
  v_mul_f32 v180, v180, v188
  v_mul_f32 v181, v181, v189
  v_mul_f32 v182, v182, v190
  v_mul_f32 v183, v183, v191
  v_cvt_pk_bf16_f32 v192, v176, v177
  v_cvt_pk_bf16_f32 v193, v178, v179
  v_cvt_pk_bf16_f32 v194, v180, v181
  v_cvt_pk_bf16_f32 v195, v182, v183
  s_lshl_b32 s42, s63, 11
  s_add_u32 s42, s42, s55
  s_add_u32 s42, s42, 0
  buffer_store_dwordx4 v[192:195], v203, s[12:15], s42 offen sc1
  v_mul_f32 v176, v123, v152
  v_mul_f32 v177, v123, v153
  v_mul_f32 v178, v123, v154
  v_mul_f32 v179, v123, v155
  v_mul_f32 v180, v123, v156
  v_mul_f32 v181, v123, v157
  v_mul_f32 v182, v123, v158
  v_mul_f32 v183, v123, v159
  v_fma_f32 v176, v40, v122, v176
  v_fma_f32 v177, v41, v122, v177
  v_fma_f32 v178, v42, v122, v178
  v_fma_f32 v179, v43, v122, v179
  v_fma_f32 v180, v44, v122, v180
  v_fma_f32 v181, v45, v122, v181
  v_fma_f32 v182, v46, v122, v182
  v_fma_f32 v183, v47, v122, v183
  v_exp_f32 v184, -v176
  v_exp_f32 v185, -v177
  v_exp_f32 v186, -v178
  v_exp_f32 v187, -v179
  v_exp_f32 v188, -v180
  v_exp_f32 v189, -v181
  v_exp_f32 v190, -v182
  v_exp_f32 v191, -v183
  v_add_f32 v184, 1.0, v184
  v_add_f32 v185, 1.0, v185
  v_add_f32 v186, 1.0, v186
  v_add_f32 v187, 1.0, v187
  v_add_f32 v188, 1.0, v188
  v_add_f32 v189, 1.0, v189
  v_add_f32 v190, 1.0, v190
  v_add_f32 v191, 1.0, v191
  v_rcp_f32 v184, v184
  v_rcp_f32 v185, v185
  v_rcp_f32 v186, v186
  v_rcp_f32 v187, v187
  v_rcp_f32 v188, v188
  v_rcp_f32 v189, v189
  v_rcp_f32 v190, v190
  v_rcp_f32 v191, v191
  v_mul_f32 v176, v176, v184
  v_mul_f32 v177, v177, v185
  v_mul_f32 v178, v178, v186
  v_mul_f32 v179, v179, v187
  v_mul_f32 v180, v180, v188
  v_mul_f32 v181, v181, v189
  v_mul_f32 v182, v182, v190
  v_mul_f32 v183, v183, v191
  v_cvt_pk_bf16_f32 v196, v176, v177
  v_cvt_pk_bf16_f32 v197, v178, v179
  v_cvt_pk_bf16_f32 v198, v180, v181
  v_cvt_pk_bf16_f32 v199, v182, v183
  s_lshl_b32 s42, s63, 11
  s_add_u32 s42, s42, s55
  s_add_u32 s42, s42, 1024
  buffer_store_dwordx4 v[196:199], v203, s[12:15], s42 offen sc1
  s_waitcnt lgkmcnt(0)
  v_mul_f32 v176, v123, v160
  v_mul_f32 v177, v123, v161
  v_mul_f32 v178, v123, v162
  v_mul_f32 v179, v123, v163
  v_mul_f32 v180, v123, v164
  v_mul_f32 v181, v123, v165
  v_mul_f32 v182, v123, v166
  v_mul_f32 v183, v123, v167
  v_fma_f32 v176, v48, v122, v176
  v_fma_f32 v177, v49, v122, v177
  v_fma_f32 v178, v50, v122, v178
  v_fma_f32 v179, v51, v122, v179
  v_fma_f32 v180, v52, v122, v180
  v_fma_f32 v181, v53, v122, v181
  v_fma_f32 v182, v54, v122, v182
  v_fma_f32 v183, v55, v122, v183
  v_exp_f32 v184, -v176
  v_exp_f32 v185, -v177
  v_exp_f32 v186, -v178
  v_exp_f32 v187, -v179
  v_exp_f32 v188, -v180
  v_exp_f32 v189, -v181
  v_exp_f32 v190, -v182
  v_exp_f32 v191, -v183
  v_add_f32 v184, 1.0, v184
  v_add_f32 v185, 1.0, v185
  v_add_f32 v186, 1.0, v186
  v_add_f32 v187, 1.0, v187
  v_add_f32 v188, 1.0, v188
  v_add_f32 v189, 1.0, v189
  v_add_f32 v190, 1.0, v190
  v_add_f32 v191, 1.0, v191
  v_rcp_f32 v184, v184
  v_rcp_f32 v185, v185
  v_rcp_f32 v186, v186
  v_rcp_f32 v187, v187
  v_rcp_f32 v188, v188
  v_rcp_f32 v189, v189
  v_rcp_f32 v190, v190
  v_rcp_f32 v191, v191
  v_mul_f32 v176, v176, v184
  v_mul_f32 v177, v177, v185
  v_mul_f32 v178, v178, v186
  v_mul_f32 v179, v179, v187
  v_mul_f32 v180, v180, v188
  v_mul_f32 v181, v181, v189
  v_mul_f32 v182, v182, v190
  v_mul_f32 v183, v183, v191
  v_cvt_pk_bf16_f32 v192, v176, v177
  v_cvt_pk_bf16_f32 v193, v178, v179
  v_cvt_pk_bf16_f32 v194, v180, v181
  v_cvt_pk_bf16_f32 v195, v182, v183
  s_lshl_b32 s42, s64, 11
  s_add_u32 s42, s42, s55
  s_add_u32 s42, s42, 0
  buffer_store_dwordx4 v[192:195], v203, s[12:15], s42 offen sc1
  v_mul_f32 v176, v123, v168
  v_mul_f32 v177, v123, v169
  v_mul_f32 v178, v123, v170
  v_mul_f32 v179, v123, v171
  v_mul_f32 v180, v123, v172
  v_mul_f32 v181, v123, v173
  v_mul_f32 v182, v123, v174
  v_mul_f32 v183, v123, v175
  v_fma_f32 v176, v56, v122, v176
  v_fma_f32 v177, v57, v122, v177
  v_fma_f32 v178, v58, v122, v178
  v_fma_f32 v179, v59, v122, v179
  v_fma_f32 v180, v60, v122, v180
  v_fma_f32 v181, v61, v122, v181
  v_fma_f32 v182, v62, v122, v182
  v_fma_f32 v183, v63, v122, v183
  v_exp_f32 v184, -v176
  v_exp_f32 v185, -v177
  v_exp_f32 v186, -v178
  v_exp_f32 v187, -v179
  v_exp_f32 v188, -v180
  v_exp_f32 v189, -v181
  v_exp_f32 v190, -v182
  v_exp_f32 v191, -v183
  v_add_f32 v184, 1.0, v184
  v_add_f32 v185, 1.0, v185
  v_add_f32 v186, 1.0, v186
  v_add_f32 v187, 1.0, v187
  v_add_f32 v188, 1.0, v188
  v_add_f32 v189, 1.0, v189
  v_add_f32 v190, 1.0, v190
  v_add_f32 v191, 1.0, v191
  v_rcp_f32 v184, v184
  v_rcp_f32 v185, v185
  v_rcp_f32 v186, v186
  v_rcp_f32 v187, v187
  v_rcp_f32 v188, v188
  v_rcp_f32 v189, v189
  v_rcp_f32 v190, v190
  v_rcp_f32 v191, v191
  v_mul_f32 v176, v176, v184
  v_mul_f32 v177, v177, v185
  v_mul_f32 v178, v178, v186
  v_mul_f32 v179, v179, v187
  v_mul_f32 v180, v180, v188
  v_mul_f32 v181, v181, v189
  v_mul_f32 v182, v182, v190
  v_mul_f32 v183, v183, v191
  v_cvt_pk_bf16_f32 v196, v176, v177
  v_cvt_pk_bf16_f32 v197, v178, v179
  v_cvt_pk_bf16_f32 v198, v180, v181
  v_cvt_pk_bf16_f32 v199, v182, v183
  s_lshl_b32 s42, s64, 11
  s_add_u32 s42, s42, s55
  s_add_u32 s42, s42, 1024
  buffer_store_dwordx4 v[196:199], v203, s[12:15], s42 offen sc1
  s_waitcnt vmcnt(0)
  s_lshl_b32 s42, s34, 1
  s_lshr_b32 s43, s33, 1
  s_add_u32 s42, s42, s43
  s_lshl_b32 s42, s42, 7
  s_lshl_b32 s43, s35, 1
  s_and_b32 s44, s33, 1
  s_add_u32 s43, s43, s44
  s_lshl_b32 s43, s43, 2
  s_add_u32 s40, s42, s43
  s_add_u32 s40, s40, 4096
  v_mov_b32 v2, 0
  v_mov_b32 v3, s1
  s_mov_b64 exec, 1
  buffer_store_dword v3, v2, s[12:15], s40 offen sc1
  s_mov_b64 exec, -1
  s_endpgm
L_Bend0:
L_BQ:
  v_lshrrev_b32 v2, 3, v1
  v_lshlrev_b32 v5, 10, v2
  v_and_b32 v3, 7, v1
  v_lshrrev_b32 v4, 4, v1
  v_xor_b32 v6, v3, v4
  v_lshlrev_b32 v6, 4, v6
  v_add_u32 v104, v5, v6
  v_xor_b32 v105, 64, v104
  v_mul_lo_u32 v2, v2, s38
  v_and_b32 v4, 1, v4
  v_lshlrev_b32 v4, 2, v4
  v_xor_b32 v3, v3, v4
  v_lshlrev_b32 v3, 4, v3
  v_add_u32 v106, v2, v3
  v_mov_b32 v48, v104
  v_add_u32 v49, 7168, v105
  v_add_u32 v50, 14336, v104
  v_add_u32 v51, 21504, v105
  s_lshl_b32 s45, s38, 3
  s_sub_u32 s45, s45, 1024
  v_mov_b32 v52, v106
  v_add_u32 v53, s45, v52
  v_add_u32 v54, s45, v53
  v_add_u32 v55, s45, v54
  s_lshl_b32 s40, s34, 7
  s_lshl_b32 s41, s33, 5
  s_add_u32 s40, s40, s41
  s_lshl_b32 s46, s40, 10
  s_lshl_b32 s48, s33, 12
  s_lshr_b32 s40, s33, 1
  s_and_b32 s41, s33, 1
  s_lshl_b32 s42, s41, 5
  s_mul_i32 s42, s42, s38
  s_lshl_b32 s43, s58, 1
  s_lshl_b32 s44, s40, 10
  s_add_u32 s43, s43, s44
  s_add_u32 s47, s42, s43
  s_lshl_b32 s42, s40, 13
  s_lshl_b32 s43, s41, 12
  s_add_u32 s49, s42, s43
  s_add_u32 s49, s49, 16384
  s_add_u32 s40, s37, 0
  s_and_b32 s40, s40, 7
  s_lshl_b32 s41, s40, 7
  s_add_u32 s50, s46, s41
  s_mul_i32 s41, s40, s54
  s_add_u32 s51, s47, s41
  s_add_u32 m0, s48, 0
  s_nop 0
  buffer_load_dwordx4 v48, s[4:7], s50 offen offset:0 lds
  buffer_load_dwordx4 v49, s[4:7], s50 offen offset:1024 lds
  buffer_load_dwordx4 v50, s[4:7], s50 offen offset:2048 lds
  buffer_load_dwordx4 v51, s[4:7], s50 offen offset:3072 lds
  s_add_u32 m0, s49, 0
  s_nop 0
  buffer_load_dwordx4 v52, s[8:11], s51 offen offset:0 lds
  buffer_load_dwordx4 v53, s[8:11], s51 offen offset:1024 lds
  buffer_load_dwordx4 v54, s[8:11], s51 offen offset:2048 lds
  buffer_load_dwordx4 v55, s[8:11], s51 offen offset:3072 lds
  s_add_u32 s40, s37, 1
  s_and_b32 s40, s40, 7
  s_lshl_b32 s41, s40, 7
  s_add_u32 s50, s46, s41
  s_mul_i32 s41, s40, s54
  s_add_u32 s51, s47, s41
  s_add_u32 m0, s48, 32768
  s_nop 0
  buffer_load_dwordx4 v48, s[4:7], s50 offen offset:0 lds
  buffer_load_dwordx4 v49, s[4:7], s50 offen offset:1024 lds
  buffer_load_dwordx4 v50, s[4:7], s50 offen offset:2048 lds
  buffer_load_dwordx4 v51, s[4:7], s50 offen offset:3072 lds
  s_add_u32 m0, s49, 32768
  s_nop 0
  buffer_load_dwordx4 v52, s[8:11], s51 offen offset:0 lds
  buffer_load_dwordx4 v53, s[8:11], s51 offen offset:1024 lds
  buffer_load_dwordx4 v54, s[8:11], s51 offen offset:2048 lds
  buffer_load_dwordx4 v55, s[8:11], s51 offen offset:3072 lds
  s_add_u32 s40, s37, 2
  s_and_b32 s40, s40, 7
  s_lshl_b32 s41, s40, 7
  s_add_u32 s50, s46, s41
  s_mul_i32 s41, s40, s54
  s_add_u32 s51, s47, s41
  s_add_u32 m0, s48, 65536
  s_nop 0
  buffer_load_dwordx4 v48, s[4:7], s50 offen offset:0 lds
  buffer_load_dwordx4 v49, s[4:7], s50 offen offset:1024 lds
  buffer_load_dwordx4 v50, s[4:7], s50 offen offset:2048 lds
  buffer_load_dwordx4 v51, s[4:7], s50 offen offset:3072 lds
  s_add_u32 m0, s49, 65536
  s_nop 0
  buffer_load_dwordx4 v52, s[8:11], s51 offen offset:0 lds
  buffer_load_dwordx4 v53, s[8:11], s51 offen offset:1024 lds
  buffer_load_dwordx4 v54, s[8:11], s51 offen offset:2048 lds
  buffer_load_dwordx4 v55, s[8:11], s51 offen offset:3072 lds
  s_mov_b32 s12, s92
  s_mov_b32 s13, s93
  s_mov_b32 s14, 16777216
  s_mov_b32 s15, 0x20000
  s_mov_b32 s16, s86
  s_mov_b32 s17, s87
  s_mov_b32 s18, 1835008
  s_mov_b32 s19, 0x20000
  s_mov_b32 s20, s80
  s_mov_b32 s21, s81
  s_mov_b32 s22, 524288
  s_mov_b32 s23, 0x20000
  s_mov_b32 s24, s88
  s_mov_b32 s25, s89
  s_mov_b32 s26, 2097152
  s_mov_b32 s27, 0x20000
  s_mov_b32 s28, s90
  s_mov_b32 s29, s91
  s_mov_b32 s30, 256
  s_mov_b32 s31, 0x20000
  s_mov_b32 s70, 0x3f317218
  s_mov_b32 s71, 0x35c1a2a0
  v_and_b32 v2, 31, v1
  v_lshrrev_b32 v3, 5, v1
  v_lshrrev_b32 v4, 1, v2
  v_and_b32 v4, 7, v4
  v_xor_b32 v4, v4, v3
  v_lshlrev_b32 v4, 4, v4
  v_lshlrev_b32 v5, 7, v2
  v_add_u32 v4, v4, v5
  v_add_u32 v4, s48, v4
  v_xor_b32 v110, 0, v4
  v_xor_b32 v111, 32, v4
  v_xor_b32 v112, 64, v4
  v_xor_b32 v113, 96, v4
  s_lshl_b32 s40, s33, 4
  s_mul_i32 s40, s40, s38
  s_lshl_b32 s41, s59, 1
  s_add_u32 s52, s40, s41
  s_lshl_b32 s53, s33, 11
  v_mov_b32 v107, v106
  s_lshl_b32 s45, s38, 3
  s_sub_u32 s45, s45, 1024
  v_add_u32 v108, s45, v106
  v_lshrrev_b32 v2, 5, v1
  v_lshlrev_b32 v2, 3, v2
  v_and_b32 v3, 15, v1
  v_lshrrev_b32 v4, 2, v3
  v_add_u32 v2, v2, v4
  v_lshlrev_b32 v2, 7, v2
  v_lshrrev_b32 v4, 3, v3
  v_lshlrev_b32 v4, 6, v4
  v_add_u32 v2, v2, v4
  v_lshrrev_b32 v4, 4, v1
  v_and_b32 v4, 1, v4
  v_lshlrev_b32 v4, 5, v4
  v_add_u32 v2, v2, v4
  v_and_b32 v4, 3, v3
  v_lshlrev_b32 v4, 3, v4
  v_add_u32 v2, v2, v4
  s_and_b32 s40, s33, 1
  s_lshl_b32 s40, s40, 6
  v_xor_b32 v114, s40, v2
  v_xor_b32 v115, 64, v114
  v_and_b32 v2, 15, v1
  v_lshrrev_b32 v3, 4, v1
  v_and_b32 v3, 1, v3
  v_cmp_eq_u32 vcc, v2, v3
  v_mov_b32 v2, 0x3f803f80
  s_nop 0
  v_cndmask_b32 v118, 0, v2, vcc
  v_mov_b32 v119, v118
  v_mov_b32 v120, v118
  v_mov_b32 v121, v118
  s_lshl_b32 s43, s34, 11
  s_lshl_b32 s44, s33, 9
  s_add_u32 s43, s43, s44
  s_add_u32 s43, s43, 196608
  v_and_b32 v2, 31, v1
  v_lshlrev_b32 v2, 4, v2
  v_add_u32 v16, s43, v2
  s_lshl_b32 s42, s36, 3
  s_add_u32 s42, s42, s35
  s_lshl_b32 s43, s42, 14
  s_add_u32 s43, s43, 262144
  s_lshl_b32 s44, s33, 8
  s_add_u32 s43, s43, s44
  v_lshrrev_b32 v2, 5, v1
  v_lshlrev_b32 v2, 13, v2
  v_and_b32 v3, 31, v1
  v_lshlrev_b32 v3, 3, v3
  v_add_u32 v2, v2, v3
  v_add_u32 v17, s43, v2
  s_mov_b32 s56, 4096
  s_waitcnt vmcnt(16) lgkmcnt(0)
  s_barrier
  v_add_u32 v124, 0, v110
  ds_read_b128 v[128:131], v124
  v_add_u32 v125, 0, v111
  ds_read_b128 v[132:135], v125
  v_add_u32 v126, 0, v112
  ds_read_b128 v[136:139], v126
  v_add_u32 v127, 0, v113
  ds_read_b128 v[140:143], v127
  v_mov_b32 v3, 157680
  ds_read_b32 v4, v3
  s_waitcnt lgkmcnt(0)
  v_readfirstlane_b32 s1, v4
  s_add_u32 s40, s37, 3
  s_and_b32 s40, s40, 7
  s_lshl_b32 s41, s40, 7
  s_add_u32 s50, s46, s41
  s_mul_i32 s41, s40, s54
  s_add_u32 s51, s47, s41
  s_add_u32 m0, s48, 98304
  s_nop 0
  buffer_load_dwordx4 v48, s[4:7], s50 offen offset:0 lds
  buffer_load_dwordx4 v49, s[4:7], s50 offen offset:1024 lds
  buffer_load_dwordx4 v50, s[4:7], s50 offen offset:2048 lds
  buffer_load_dwordx4 v51, s[4:7], s50 offen offset:3072 lds
  s_add_u32 m0, s49, 98304
  s_nop 0
  buffer_load_dwordx4 v52, s[8:11], s51 offen offset:0 lds
  buffer_load_dwordx4 v53, s[8:11], s51 offen offset:1024 lds
  buffer_load_dwordx4 v54, s[8:11], s51 offen offset:2048 lds
  buffer_load_dwordx4 v55, s[8:11], s51 offen offset:3072 lds
  s_waitcnt vmcnt(16) lgkmcnt(0)
  s_barrier
  v_add_u32 v124, 32768, v110
  ds_read_b128 v[144:147], v124
  v_add_u32 v125, 32768, v111
  ds_read_b128 v[148:151], v125
  v_add_u32 v126, 32768, v112
  ds_read_b128 v[152:155], v126
  v_add_u32 v127, 32768, v113
  ds_read_b128 v[156:159], v127
  s_add_u32 s40, s37, 4
  s_and_b32 s40, s40, 7
  s_lshl_b32 s41, s40, 7
  s_add_u32 s50, s46, s41
  s_mul_i32 s41, s40, s54
  s_add_u32 s51, s47, s41
  s_add_u32 m0, s48, 0
  s_nop 0
  buffer_load_dwordx4 v48, s[4:7], s50 offen offset:0 lds
  buffer_load_dwordx4 v49, s[4:7], s50 offen offset:1024 lds
  buffer_load_dwordx4 v50, s[4:7], s50 offen offset:2048 lds
  buffer_load_dwordx4 v51, s[4:7], s50 offen offset:3072 lds
  s_add_u32 m0, s49, 0
  s_nop 0
  buffer_load_dwordx4 v52, s[8:11], s51 offen offset:0 lds
  buffer_load_dwordx4 v53, s[8:11], s51 offen offset:1024 lds
  buffer_load_dwordx4 v54, s[8:11], s51 offen offset:2048 lds
  buffer_load_dwordx4 v55, s[8:11], s51 offen offset:3072 lds
  s_waitcnt vmcnt(16) lgkmcnt(0)
  s_barrier
  v_add_u32 v124, 65536, v110
  ds_read_b128 v[160:163], v124
  v_add_u32 v125, 65536, v111
  ds_read_b128 v[164:167], v125
  v_add_u32 v126, 65536, v112
  ds_read_b128 v[168:171], v126
  v_add_u32 v127, 65536, v113
  ds_read_b128 v[172:175], v127
  s_add_u32 s40, s37, 5
  s_and_b32 s40, s40, 7
  s_lshl_b32 s41, s40, 7
  s_add_u32 s50, s46, s41
  s_mul_i32 s41, s40, s54
  s_add_u32 s51, s47, s41
  s_add_u32 m0, s48, 32768
  s_nop 0
  buffer_load_dwordx4 v48, s[4:7], s50 offen offset:0 lds
  buffer_load_dwordx4 v49, s[4:7], s50 offen offset:1024 lds
  buffer_load_dwordx4 v50, s[4:7], s50 offen offset:2048 lds
  buffer_load_dwordx4 v51, s[4:7], s50 offen offset:3072 lds
  s_add_u32 m0, s49, 32768
  s_nop 0
  buffer_load_dwordx4 v52, s[8:11], s51 offen offset:0 lds
  buffer_load_dwordx4 v53, s[8:11], s51 offen offset:1024 lds
  buffer_load_dwordx4 v54, s[8:11], s51 offen offset:2048 lds
  buffer_load_dwordx4 v55, s[8:11], s51 offen offset:3072 lds
  v_and_b32 v2, 15, v1
  v_lshlrev_b32 v3, 3, v2
  s_lshl_b32 s40, s33, 7
  s_add_u32 s40, s40, 157696
  v_add_u32 v3, s40, v3
  ds_read_b64 v[44:45], v3
  s_lshl_b32 s40, s36, 3
  s_add_u32 s40, s40, s35
  s_lshl_b32 s40, s40, 4
  s_add_u32 s40, s40, s34
  s_lshl_b32 s40, s40, 10
  s_add_u32 s40, s40, 262144
  s_lshl_b32 s41, s33, 8
  s_add_u32 s40, s40, s41
  v_lshlrev_b32 v2, 4, v2
  s_waitcnt lgkmcnt(0)
  v_mov_b32 v46, v45
  v_mov_b32 v45, s1
  v_mov_b32 v47, s1
  s_mov_b64 exec, 0xffff
  buffer_store_dwordx4 v[44:47], v2, s[12:15], s40 offen sc1
  s_mov_b64 exec, -1
  v_and_b32 v2, 31, v1
  v_lshlrev_b32 v2, 2, v2
  buffer_load_dword v40, v2, s[28:31], 0 offen sc1
  s_waitcnt vmcnt(18) lgkmcnt(0)
  s_barrier
  v_add_u32 v124, 98304, v110
  ds_read_b128 v[176:179], v124
  v_add_u32 v125, 98304, v111
  ds_read_b128 v[180:183], v125
  v_add_u32 v126, 98304, v112
  ds_read_b128 v[184:187], v126
  v_add_u32 v127, 98304, v113
  ds_read_b128 v[188:191], v127
  s_add_u32 s40, s37, 6
  s_and_b32 s40, s40, 7
  s_lshl_b32 s41, s40, 7
  s_add_u32 s50, s46, s41
  s_mul_i32 s41, s40, s54
  s_add_u32 s51, s47, s41
  s_add_u32 m0, s48, 65536
  s_nop 0
  buffer_load_dwordx4 v48, s[4:7], s50 offen offset:0 lds
  buffer_load_dwordx4 v49, s[4:7], s50 offen offset:1024 lds
  buffer_load_dwordx4 v50, s[4:7], s50 offen offset:2048 lds
  buffer_load_dwordx4 v51, s[4:7], s50 offen offset:3072 lds
  s_add_u32 m0, s49, 65536
  s_nop 0
  buffer_load_dwordx4 v52, s[8:11], s51 offen offset:0 lds
  buffer_load_dwordx4 v53, s[8:11], s51 offen offset:1024 lds
  buffer_load_dwordx4 v54, s[8:11], s51 offen offset:2048 lds
  buffer_load_dwordx4 v55, s[8:11], s51 offen offset:3072 lds
  s_waitcnt vmcnt(18) lgkmcnt(0)
  s_barrier
  v_add_u32 v124, 0, v110
  ds_read_b128 v[192:195], v124
  v_add_u32 v125, 0, v111
  ds_read_b128 v[196:199], v125
  v_add_u32 v126, 0, v112
  ds_read_b128 v[200:203], v126
  v_add_u32 v127, 0, v113
  ds_read_b128 v[204:207], v127
  s_add_u32 s40, s37, 7
  s_and_b32 s40, s40, 7
  s_lshl_b32 s41, s40, 7
  s_add_u32 s50, s46, s41
  s_mul_i32 s41, s40, s54
  s_add_u32 s51, s47, s41
  s_add_u32 m0, s48, 98304
  s_nop 0
  buffer_load_dwordx4 v48, s[4:7], s50 offen offset:0 lds
  buffer_load_dwordx4 v49, s[4:7], s50 offen offset:1024 lds
  buffer_load_dwordx4 v50, s[4:7], s50 offen offset:2048 lds
  buffer_load_dwordx4 v51, s[4:7], s50 offen offset:3072 lds
  s_add_u32 m0, s49, 98304
  s_nop 0
  buffer_load_dwordx4 v52, s[8:11], s51 offen offset:0 lds
  buffer_load_dwordx4 v53, s[8:11], s51 offen offset:1024 lds
  buffer_load_dwordx4 v54, s[8:11], s51 offen offset:2048 lds
  buffer_load_dwordx4 v55, s[8:11], s51 offen offset:3072 lds
  s_waitcnt vmcnt(18) lgkmcnt(0)
  s_barrier
  v_add_u32 v124, 32768, v110
  ds_read_b128 v[208:211], v124
  v_add_u32 v125, 32768, v111
  ds_read_b128 v[212:215], v125
  v_add_u32 v126, 32768, v112
  ds_read_b128 v[216:219], v126
  v_add_u32 v127, 32768, v113
  ds_read_b128 v[220:223], v127
  s_add_u32 s40, s37, 0
  s_and_b32 s40, s40, 7
  s_mul_i32 s41, s40, s54
  s_add_u32 s51, s52, s41
  s_add_u32 m0, s53, 0
  s_nop 0
  buffer_load_dwordx4 v107, s[8:11], s51 offen offset:0 lds
  buffer_load_dwordx4 v108, s[8:11], s51 offen offset:1024 lds
  s_add_u32 s40, s37, 1
  s_and_b32 s40, s40, 7
  s_mul_i32 s41, s40, s54
  s_add_u32 s51, s52, s41
  s_add_u32 m0, s53, 8192
  s_nop 0
  buffer_load_dwordx4 v107, s[8:11], s51 offen offset:0 lds
  buffer_load_dwordx4 v108, s[8:11], s51 offen offset:1024 lds
  s_waitcnt vmcnt(12) lgkmcnt(0)
  s_barrier
  v_add_u32 v124, 65536, v110
  ds_read_b128 v[224:227], v124
  v_add_u32 v125, 65536, v111
  ds_read_b128 v[228:231], v125
  v_add_u32 v126, 65536, v112
  ds_read_b128 v[232:235], v126
  v_add_u32 v127, 65536, v113
  ds_read_b128 v[236:239], v127
  s_add_u32 s40, s37, 2
  s_and_b32 s40, s40, 7
  s_mul_i32 s41, s40, s54
  s_add_u32 s51, s52, s41
  s_add_u32 m0, s53, 16384
  s_nop 0
  buffer_load_dwordx4 v107, s[8:11], s51 offen offset:0 lds
  buffer_load_dwordx4 v108, s[8:11], s51 offen offset:1024 lds
  s_add_u32 s40, s37, 3
  s_and_b32 s40, s40, 7
  s_mul_i32 s41, s40, s54
  s_add_u32 s51, s52, s41
  s_add_u32 m0, s53, 24576
  s_nop 0
  buffer_load_dwordx4 v107, s[8:11], s51 offen offset:0 lds
  buffer_load_dwordx4 v108, s[8:11], s51 offen offset:1024 lds
  buffer_load_dwordx4 v[36:39], v16, s[12:15], 0 offen sc1
  buffer_load_dwordx2 v[20:21], v17, s[12:15], 0 offen offset:0 sc1
  buffer_load_dwordx2 v[22:23], v17, s[12:15], 0 offen offset:1024 sc1
  buffer_load_dwordx2 v[24:25], v17, s[12:15], 0 offen offset:2048 sc1
  buffer_load_dwordx2 v[26:27], v17, s[12:15], 0 offen offset:3072 sc1
  buffer_load_dwordx2 v[28:29], v17, s[12:15], s56 offen offset:0 sc1
  buffer_load_dwordx2 v[30:31], v17, s[12:15], s56 offen offset:1024 sc1
  buffer_load_dwordx2 v[32:33], v17, s[12:15], s56 offen offset:2048 sc1
  buffer_load_dwordx2 v[34:35], v17, s[12:15], s56 offen offset:3072 sc1
  s_waitcnt vmcnt(17) lgkmcnt(0)
  s_barrier
  v_add_u32 v124, 98304, v110
  ds_read_b128 v[240:243], v124
  v_add_u32 v125, 98304, v111
  ds_read_b128 v[244:247], v125
  v_add_u32 v126, 98304, v112
  ds_read_b128 v[248:251], v126
  v_add_u32 v127, 98304, v113
  ds_read_b128 v[252:255], v127
  s_waitcnt vmcnt(0)
  s_mov_b32 s3, 0
L_tg_6:
  v_xor_b32 v2, s1, v38
  v_xor_b32 v3, s1, v21
  v_or_b32 v2, v2, v3
  v_xor_b32 v3, s1, v23
  v_or_b32 v2, v2, v3
  v_xor_b32 v3, s1, v25
  v_or_b32 v2, v2, v3
  v_xor_b32 v3, s1, v27
  v_or_b32 v2, v2, v3
  v_xor_b32 v3, s1, v29
  v_or_b32 v2, v2, v3
  v_xor_b32 v3, s1, v31
  v_or_b32 v2, v2, v3
  v_xor_b32 v3, s1, v33
  v_or_b32 v2, v2, v3
  v_xor_b32 v3, s1, v35
  v_or_b32 v2, v2, v3
  v_cmp_ne_u32 vcc, 0, v2
  s_nop 0
  s_cbranch_vccz L_tg_6x
  s_add_u32 s3, s3, 1
  s_cmp_gt_u32 s3, 20000
  s_cbranch_scc1 L_tg_6x
  buffer_load_dwordx4 v[36:39], v16, s[12:15], 0 offen sc1
  buffer_load_dwordx2 v[20:21], v17, s[12:15], 0 offen offset:0 sc1
  buffer_load_dwordx2 v[22:23], v17, s[12:15], 0 offen offset:1024 sc1
  buffer_load_dwordx2 v[24:25], v17, s[12:15], 0 offen offset:2048 sc1
  buffer_load_dwordx2 v[26:27], v17, s[12:15], 0 offen offset:3072 sc1
  buffer_load_dwordx2 v[28:29], v17, s[12:15], s56 offen offset:0 sc1
  buffer_load_dwordx2 v[30:31], v17, s[12:15], s56 offen offset:1024 sc1
  buffer_load_dwordx2 v[32:33], v17, s[12:15], s56 offen offset:2048 sc1
  buffer_load_dwordx2 v[34:35], v17, s[12:15], s56 offen offset:3072 sc1
  s_waitcnt vmcnt(0)
  s_branch L_tg_6
L_tg_6x:
  v_and_b32 v2, 31, v1
  v_lshlrev_b32 v2, 2, v2
  v_cmp_ne_u32 vcc, 1, v40
  s_nop 0
  s_cbranch_vccz L_pc_7x
  s_mov_b32 s3, 0
L_pc_7:
  s_add_u32 s3, s3, 1
  s_cmp_gt_u32 s3, 20000
  s_cbranch_scc1 L_pc_7x
  buffer_load_dword v40, v2, s[28:31], 0 offen sc1
  s_waitcnt vmcnt(0)
  v_cmp_ne_u32 vcc, 1, v40
  s_nop 0
  s_cbranch_vccnz L_pc_7
L_pc_7x:
  s_lshl_b32 s40, s33, 7
  s_add_u32 s40, s40, 155648
  v_add_u32 v3, s40, v2
  ds_write_b32 v3, v36
  ds_write_b32 v3, v37 offset:512
  v_add_f32 v20, v20, v28
  v_add_f32 v22, v22, v30
  v_add_f32 v24, v24, v32
  v_add_f32 v26, v26, v34
  v_add_f32 v20, v20, v24
  v_add_f32 v22, v22, v26
  v_add_f32 v20, v20, v22
  v_mov_b32 v4, v20
  s_nop 1
  v_permlane32_swap_b32 v4, v20
  v_add_f32 v20, v20, v4
  s_lshl_b32 s40, s33, 7
  s_add_u32 s40, s40, 156672
  v_add_u32 v3, s40, v2
  ds_write_b32 v3, v20
L_Bpb1:
  s_waitcnt vmcnt(13) lgkmcnt(0)
  s_barrier
  v_add_u32 v124, 0, v114
  v_add_u32 v125, 0, v115
  ds_read_b64_tr_b16 v[64:65], v124 offset:0
  ds_read_b64_tr_b16 v[66:67], v124 offset:512
  ds_read_b64_tr_b16 v[68:69], v125 offset:0
  ds_read_b64_tr_b16 v[70:71], v125 offset:512
  ds_read_b64_tr_b16 v[76:77], v124 offset:2048
  ds_read_b64_tr_b16 v[78:79], v124 offset:2560
  ds_read_b64_tr_b16 v[80:81], v125 offset:2048
  ds_read_b64_tr_b16 v[82:83], v125 offset:2560
  s_waitcnt lgkmcnt(4)
  v_mfma_f32_32x32x16_bf16 v[16:31], v[64:67], v[128:131], 0
  s_add_u32 s40, s37, 4
  s_and_b32 s40, s40, 7
  s_mul_i32 s41, s40, s54
  s_add_u32 s51, s52, s41
  s_add_u32 m0, s53, 32768
  s_nop 0
  buffer_load_dwordx4 v107, s[8:11], s51 offen offset:0 lds
  buffer_load_dwordx4 v108, s[8:11], s51 offen offset:1024 lds
  ds_read_b64_tr_b16 v[88:89], v124 offset:4096
  ds_read_b64_tr_b16 v[90:91], v124 offset:4608
  v_mfma_f32_32x32x16_bf16 v[32:47], v[68:71], v[128:131], 0
  ds_read_b64_tr_b16 v[92:93], v125 offset:4096
  ds_read_b64_tr_b16 v[94:95], v125 offset:4608
  v_mfma_f32_16x16x32_bf16 v[100:103], v[64:67], v[118:121], 0
  s_waitcnt lgkmcnt(4)
  v_mfma_f32_32x32x16_bf16 v[16:31], v[76:79], v[132:135], v[16:31]
  s_add_u32 s40, s37, 5
  s_and_b32 s40, s40, 7
  s_mul_i32 s41, s40, s54
  s_add_u32 s51, s52, s41
  s_add_u32 m0, s53, 40960
  s_nop 0
  buffer_load_dwordx4 v107, s[8:11], s51 offen offset:0 lds
  buffer_load_dwordx4 v108, s[8:11], s51 offen offset:1024 lds
  ds_read_b64_tr_b16 v[64:65], v124 offset:6144
  ds_read_b64_tr_b16 v[66:67], v124 offset:6656
  v_mfma_f32_32x32x16_bf16 v[32:47], v[80:83], v[132:135], v[32:47]
  ds_read_b64_tr_b16 v[68:69], v125 offset:6144
  ds_read_b64_tr_b16 v[70:71], v125 offset:6656
  v_mfma_f32_16x16x32_bf16 v[100:103], v[76:79], v[118:121], v[100:103]
  s_waitcnt lgkmcnt(4)
  v_mfma_f32_32x32x16_bf16 v[16:31], v[88:91], v[136:139], v[16:31]
  s_add_u32 s40, s37, 6
  s_and_b32 s40, s40, 7
  s_mul_i32 s41, s40, s54
  s_add_u32 s51, s52, s41
  s_add_u32 m0, s53, 49152
  s_nop 0
  buffer_load_dwordx4 v107, s[8:11], s51 offen offset:0 lds
  buffer_load_dwordx4 v108, s[8:11], s51 offen offset:1024 lds
  ds_read_b64_tr_b16 v[76:77], v124 offset:8192
  ds_read_b64_tr_b16 v[78:79], v124 offset:8704
  v_mfma_f32_32x32x16_bf16 v[32:47], v[92:95], v[136:139], v[32:47]
  ds_read_b64_tr_b16 v[80:81], v125 offset:8192
  ds_read_b64_tr_b16 v[82:83], v125 offset:8704
  v_mfma_f32_16x16x32_bf16 v[100:103], v[88:91], v[118:121], v[100:103]
  s_waitcnt lgkmcnt(4)
  v_mfma_f32_32x32x16_bf16 v[16:31], v[64:67], v[140:143], v[16:31]
  s_add_u32 s40, s37, 7
  s_and_b32 s40, s40, 7
  s_mul_i32 s41, s40, s54
  s_add_u32 s51, s52, s41
  s_add_u32 m0, s53, 57344
  s_nop 0
  buffer_load_dwordx4 v107, s[8:11], s51 offen offset:0 lds
  buffer_load_dwordx4 v108, s[8:11], s51 offen offset:1024 lds
  ds_read_b64_tr_b16 v[88:89], v124 offset:10240
  ds_read_b64_tr_b16 v[90:91], v124 offset:10752
  v_mfma_f32_32x32x16_bf16 v[32:47], v[68:71], v[140:143], v[32:47]
  ds_read_b64_tr_b16 v[92:93], v125 offset:10240
  ds_read_b64_tr_b16 v[94:95], v125 offset:10752
  v_mfma_f32_16x16x32_bf16 v[100:103], v[64:67], v[118:121], v[100:103]
  s_waitcnt lgkmcnt(4)
  v_mfma_f32_32x32x16_bf16 v[16:31], v[76:79], v[144:147], v[16:31]
  s_waitcnt vmcnt(17)
  v_mov_b32 v2, 157672
  v_mov_b32 v3, 1
  s_mov_b64 exec, 1
  ds_add_u32 v2, v3
  s_mov_b64 exec, -1
  ds_read_b64_tr_b16 v[64:65], v124 offset:12288
  ds_read_b64_tr_b16 v[66:67], v124 offset:12800
  v_mfma_f32_32x32x16_bf16 v[32:47], v[80:83], v[144:147], v[32:47]
  ds_read_b64_tr_b16 v[68:69], v125 offset:12288
  ds_read_b64_tr_b16 v[70:71], v125 offset:12800
  v_mfma_f32_16x16x32_bf16 v[100:103], v[76:79], v[118:121], v[100:103]
  s_waitcnt lgkmcnt(4)
  v_mfma_f32_32x32x16_bf16 v[16:31], v[88:91], v[148:151], v[16:31]
  ds_read_b64_tr_b16 v[76:77], v124 offset:14336
  ds_read_b64_tr_b16 v[78:79], v124 offset:14848
  v_mfma_f32_32x32x16_bf16 v[32:47], v[92:95], v[148:151], v[32:47]
  ds_read_b64_tr_b16 v[80:81], v125 offset:14336
  ds_read_b64_tr_b16 v[82:83], v125 offset:14848
  v_mfma_f32_16x16x32_bf16 v[100:103], v[88:91], v[118:121], v[100:103]
  s_waitcnt lgkmcnt(4)
  v_mfma_f32_32x32x16_bf16 v[16:31], v[64:67], v[152:155], v[16:31]
  v_mov_b32 v2, 157672
  s_mov_b32 s3, 0
L_cw_8:
  ds_read_b32 v3, v2
  s_waitcnt lgkmcnt(0)
  v_readfirstlane_b32 s43, v3
  s_nop 0
  s_cmp_ge_u32 s43, 4
  s_cbranch_scc1 L_cw_8x
  s_sleep 1
  s_add_u32 s3, s3, 1
  s_cmp_gt_u32 s3, 160000
  s_cbranch_scc0 L_cw_8
L_cw_8x:
  ds_read_b64_tr_b16 v[88:89], v124 offset:16384
  ds_read_b64_tr_b16 v[90:91], v124 offset:16896
  v_mfma_f32_32x32x16_bf16 v[32:47], v[68:71], v[152:155], v[32:47]
  ds_read_b64_tr_b16 v[92:93], v125 offset:16384
  ds_read_b64_tr_b16 v[94:95], v125 offset:16896
  v_mfma_f32_16x16x32_bf16 v[100:103], v[64:67], v[118:121], v[100:103]
  s_waitcnt lgkmcnt(4)
  v_mfma_f32_32x32x16_bf16 v[16:31], v[76:79], v[156:159], v[16:31]
  ds_read_b64_tr_b16 v[64:65], v124 offset:18432
  ds_read_b64_tr_b16 v[66:67], v124 offset:18944
  v_mfma_f32_32x32x16_bf16 v[32:47], v[80:83], v[156:159], v[32:47]
  ds_read_b64_tr_b16 v[68:69], v125 offset:18432
  ds_read_b64_tr_b16 v[70:71], v125 offset:18944
  v_mfma_f32_16x16x32_bf16 v[100:103], v[76:79], v[118:121], v[100:103]
  s_waitcnt lgkmcnt(4)
  v_mfma_f32_32x32x16_bf16 v[16:31], v[88:91], v[160:163], v[16:31]
  ds_read_b64_tr_b16 v[76:77], v124 offset:20480
  ds_read_b64_tr_b16 v[78:79], v124 offset:20992
  v_mfma_f32_32x32x16_bf16 v[32:47], v[92:95], v[160:163], v[32:47]
  ds_read_b64_tr_b16 v[80:81], v125 offset:20480
  ds_read_b64_tr_b16 v[82:83], v125 offset:20992
  v_mfma_f32_16x16x32_bf16 v[100:103], v[88:91], v[118:121], v[100:103]
  s_waitcnt lgkmcnt(4)
  v_mfma_f32_32x32x16_bf16 v[16:31], v[64:67], v[164:167], v[16:31]
  ds_read_b64_tr_b16 v[88:89], v124 offset:22528
  ds_read_b64_tr_b16 v[90:91], v124 offset:23040
  v_mfma_f32_32x32x16_bf16 v[32:47], v[68:71], v[164:167], v[32:47]
  ds_read_b64_tr_b16 v[92:93], v125 offset:22528
  ds_read_b64_tr_b16 v[94:95], v125 offset:23040
  v_mfma_f32_16x16x32_bf16 v[100:103], v[64:67], v[118:121], v[100:103]
  s_waitcnt lgkmcnt(4)
  v_mfma_f32_32x32x16_bf16 v[16:31], v[76:79], v[168:171], v[16:31]
  ds_read_b64_tr_b16 v[64:65], v124 offset:24576
  ds_read_b64_tr_b16 v[66:67], v124 offset:25088
  v_mfma_f32_32x32x16_bf16 v[32:47], v[80:83], v[168:171], v[32:47]
  ds_read_b64_tr_b16 v[68:69], v125 offset:24576
  ds_read_b64_tr_b16 v[70:71], v125 offset:25088
  v_mfma_f32_16x16x32_bf16 v[100:103], v[76:79], v[118:121], v[100:103]
  s_waitcnt lgkmcnt(4)
  v_mfma_f32_32x32x16_bf16 v[16:31], v[88:91], v[172:175], v[16:31]
  ds_read_b64_tr_b16 v[76:77], v124 offset:26624
  ds_read_b64_tr_b16 v[78:79], v124 offset:27136
  v_mfma_f32_32x32x16_bf16 v[32:47], v[92:95], v[172:175], v[32:47]
  ds_read_b64_tr_b16 v[80:81], v125 offset:26624
  ds_read_b64_tr_b16 v[82:83], v125 offset:27136
  v_mfma_f32_16x16x32_bf16 v[100:103], v[88:91], v[118:121], v[100:103]
  s_waitcnt lgkmcnt(4)
  v_mfma_f32_32x32x16_bf16 v[16:31], v[64:67], v[176:179], v[16:31]
  s_waitcnt vmcnt(0)
  v_mov_b32 v2, 157676
  v_mov_b32 v3, 1
  s_mov_b64 exec, 1
  ds_add_u32 v2, v3
  s_mov_b64 exec, -1
  ds_read_b64_tr_b16 v[88:89], v124 offset:28672
  ds_read_b64_tr_b16 v[90:91], v124 offset:29184
  v_mfma_f32_32x32x16_bf16 v[32:47], v[68:71], v[176:179], v[32:47]
  ds_read_b64_tr_b16 v[92:93], v125 offset:28672
  ds_read_b64_tr_b16 v[94:95], v125 offset:29184
  v_mfma_f32_16x16x32_bf16 v[100:103], v[64:67], v[118:121], v[100:103]
  s_waitcnt lgkmcnt(4)
  v_mfma_f32_32x32x16_bf16 v[16:31], v[76:79], v[180:183], v[16:31]
  ds_read_b64_tr_b16 v[64:65], v124 offset:30720
  ds_read_b64_tr_b16 v[66:67], v124 offset:31232
  v_mfma_f32_32x32x16_bf16 v[32:47], v[80:83], v[180:183], v[32:47]
  ds_read_b64_tr_b16 v[68:69], v125 offset:30720
  ds_read_b64_tr_b16 v[70:71], v125 offset:31232
  v_mfma_f32_16x16x32_bf16 v[100:103], v[76:79], v[118:121], v[100:103]
  s_waitcnt lgkmcnt(4)
  v_mfma_f32_32x32x16_bf16 v[16:31], v[88:91], v[184:187], v[16:31]
  v_mov_b32 v2, 157676
  s_mov_b32 s3, 0
L_cw_9:
  ds_read_b32 v3, v2
  s_waitcnt lgkmcnt(0)
  v_readfirstlane_b32 s43, v3
  s_nop 0
  s_cmp_ge_u32 s43, 4
  s_cbranch_scc1 L_cw_9x
  s_sleep 1
  s_add_u32 s3, s3, 1
  s_cmp_gt_u32 s3, 160000
  s_cbranch_scc0 L_cw_9
L_cw_9x:
  v_add_u32 v124, 32768, v114
  v_add_u32 v125, 32768, v115
  ds_read_b64_tr_b16 v[76:77], v124 offset:0
  ds_read_b64_tr_b16 v[78:79], v124 offset:512
  v_mfma_f32_32x32x16_bf16 v[32:47], v[92:95], v[184:187], v[32:47]
  ds_read_b64_tr_b16 v[80:81], v125 offset:0
  ds_read_b64_tr_b16 v[82:83], v125 offset:512
  v_mfma_f32_16x16x32_bf16 v[100:103], v[88:91], v[118:121], v[100:103]
  s_waitcnt lgkmcnt(4)
  v_mfma_f32_32x32x16_bf16 v[16:31], v[64:67], v[188:191], v[16:31]
  ds_read_b64_tr_b16 v[88:89], v124 offset:2048
  ds_read_b64_tr_b16 v[90:91], v124 offset:2560
  v_mfma_f32_32x32x16_bf16 v[32:47], v[68:71], v[188:191], v[32:47]
  ds_read_b64_tr_b16 v[92:93], v125 offset:2048
  ds_read_b64_tr_b16 v[94:95], v125 offset:2560
  v_mfma_f32_16x16x32_bf16 v[100:103], v[64:67], v[118:121], v[100:103]
  s_waitcnt lgkmcnt(4)
  v_mfma_f32_32x32x16_bf16 v[16:31], v[76:79], v[192:195], v[16:31]
  ds_read_b64_tr_b16 v[64:65], v124 offset:4096
  ds_read_b64_tr_b16 v[66:67], v124 offset:4608
  v_mfma_f32_32x32x16_bf16 v[32:47], v[80:83], v[192:195], v[32:47]
  ds_read_b64_tr_b16 v[68:69], v125 offset:4096
  ds_read_b64_tr_b16 v[70:71], v125 offset:4608
  v_mfma_f32_16x16x32_bf16 v[100:103], v[76:79], v[118:121], v[100:103]
  s_waitcnt lgkmcnt(4)
  v_mfma_f32_32x32x16_bf16 v[16:31], v[88:91], v[196:199], v[16:31]
  ds_read_b64_tr_b16 v[76:77], v124 offset:6144
  ds_read_b64_tr_b16 v[78:79], v124 offset:6656
  v_mfma_f32_32x32x16_bf16 v[32:47], v[92:95], v[196:199], v[32:47]
  ds_read_b64_tr_b16 v[80:81], v125 offset:6144
  ds_read_b64_tr_b16 v[82:83], v125 offset:6656
  v_mfma_f32_16x16x32_bf16 v[100:103], v[88:91], v[118:121], v[100:103]
  s_waitcnt lgkmcnt(4)
  v_mfma_f32_32x32x16_bf16 v[16:31], v[64:67], v[200:203], v[16:31]
  ds_read_b64_tr_b16 v[88:89], v124 offset:8192
  ds_read_b64_tr_b16 v[90:91], v124 offset:8704
  v_mfma_f32_32x32x16_bf16 v[32:47], v[68:71], v[200:203], v[32:47]
  ds_read_b64_tr_b16 v[92:93], v125 offset:8192
  ds_read_b64_tr_b16 v[94:95], v125 offset:8704
  v_mfma_f32_16x16x32_bf16 v[100:103], v[64:67], v[118:121], v[100:103]
  s_waitcnt lgkmcnt(4)
  v_mfma_f32_32x32x16_bf16 v[16:31], v[76:79], v[204:207], v[16:31]
  ds_read_b64_tr_b16 v[64:65], v124 offset:10240
  ds_read_b64_tr_b16 v[66:67], v124 offset:10752
  v_mfma_f32_32x32x16_bf16 v[32:47], v[80:83], v[204:207], v[32:47]
  ds_read_b64_tr_b16 v[68:69], v125 offset:10240
  ds_read_b64_tr_b16 v[70:71], v125 offset:10752
  v_mfma_f32_16x16x32_bf16 v[100:103], v[76:79], v[118:121], v[100:103]
  s_waitcnt lgkmcnt(4)
  v_mfma_f32_32x32x16_bf16 v[16:31], v[88:91], v[208:211], v[16:31]
  ds_read_b64_tr_b16 v[76:77], v124 offset:12288
  ds_read_b64_tr_b16 v[78:79], v124 offset:12800
  v_mfma_f32_32x32x16_bf16 v[32:47], v[92:95], v[208:211], v[32:47]
  ds_read_b64_tr_b16 v[80:81], v125 offset:12288
  ds_read_b64_tr_b16 v[82:83], v125 offset:12800
  v_mfma_f32_16x16x32_bf16 v[100:103], v[88:91], v[118:121], v[100:103]
  s_waitcnt lgkmcnt(4)
  v_mfma_f32_32x32x16_bf16 v[16:31], v[64:67], v[212:215], v[16:31]
  ds_read_b64_tr_b16 v[88:89], v124 offset:14336
  ds_read_b64_tr_b16 v[90:91], v124 offset:14848
  v_mfma_f32_32x32x16_bf16 v[32:47], v[68:71], v[212:215], v[32:47]
  ds_read_b64_tr_b16 v[92:93], v125 offset:14336
  ds_read_b64_tr_b16 v[94:95], v125 offset:14848
  v_mfma_f32_16x16x32_bf16 v[100:103], v[64:67], v[118:121], v[100:103]
  s_waitcnt lgkmcnt(4)
  v_mfma_f32_32x32x16_bf16 v[16:31], v[76:79], v[216:219], v[16:31]
  ds_read_b64_tr_b16 v[64:65], v124 offset:16384
  ds_read_b64_tr_b16 v[66:67], v124 offset:16896
  v_mfma_f32_32x32x16_bf16 v[32:47], v[80:83], v[216:219], v[32:47]
  ds_read_b64_tr_b16 v[68:69], v125 offset:16384
  ds_read_b64_tr_b16 v[70:71], v125 offset:16896
  v_mfma_f32_16x16x32_bf16 v[100:103], v[76:79], v[118:121], v[100:103]
  s_waitcnt lgkmcnt(4)
  v_mfma_f32_32x32x16_bf16 v[16:31], v[88:91], v[220:223], v[16:31]
  ds_read_b64_tr_b16 v[76:77], v124 offset:18432
  ds_read_b64_tr_b16 v[78:79], v124 offset:18944
  v_mfma_f32_32x32x16_bf16 v[32:47], v[92:95], v[220:223], v[32:47]
  ds_read_b64_tr_b16 v[80:81], v125 offset:18432
  ds_read_b64_tr_b16 v[82:83], v125 offset:18944
  v_mfma_f32_16x16x32_bf16 v[100:103], v[88:91], v[118:121], v[100:103]
  s_waitcnt lgkmcnt(4)
  v_mfma_f32_32x32x16_bf16 v[16:31], v[64:67], v[224:227], v[16:31]
  ds_read_b64_tr_b16 v[88:89], v124 offset:20480
  ds_read_b64_tr_b16 v[90:91], v124 offset:20992
  v_mfma_f32_32x32x16_bf16 v[32:47], v[68:71], v[224:227], v[32:47]
  ds_read_b64_tr_b16 v[92:93], v125 offset:20480
  ds_read_b64_tr_b16 v[94:95], v125 offset:20992
  v_mfma_f32_16x16x32_bf16 v[100:103], v[64:67], v[118:121], v[100:103]
  s_waitcnt lgkmcnt(4)
  v_mfma_f32_32x32x16_bf16 v[16:31], v[76:79], v[228:231], v[16:31]
  ds_read_b64_tr_b16 v[64:65], v124 offset:22528
  ds_read_b64_tr_b16 v[66:67], v124 offset:23040
  v_mfma_f32_32x32x16_bf16 v[32:47], v[80:83], v[228:231], v[32:47]
  ds_read_b64_tr_b16 v[68:69], v125 offset:22528
  ds_read_b64_tr_b16 v[70:71], v125 offset:23040
  v_mfma_f32_16x16x32_bf16 v[100:103], v[76:79], v[118:121], v[100:103]
  s_waitcnt lgkmcnt(4)
  v_mfma_f32_32x32x16_bf16 v[16:31], v[88:91], v[232:235], v[16:31]
  ds_read_b64_tr_b16 v[76:77], v124 offset:24576
  ds_read_b64_tr_b16 v[78:79], v124 offset:25088
  v_mfma_f32_32x32x16_bf16 v[32:47], v[92:95], v[232:235], v[32:47]
  ds_read_b64_tr_b16 v[80:81], v125 offset:24576
  ds_read_b64_tr_b16 v[82:83], v125 offset:25088
  v_mfma_f32_16x16x32_bf16 v[100:103], v[88:91], v[118:121], v[100:103]
  s_waitcnt lgkmcnt(4)
  v_mfma_f32_32x32x16_bf16 v[16:31], v[64:67], v[236:239], v[16:31]
  ds_read_b64_tr_b16 v[88:89], v124 offset:26624
  ds_read_b64_tr_b16 v[90:91], v124 offset:27136
  v_mfma_f32_32x32x16_bf16 v[32:47], v[68:71], v[236:239], v[32:47]
  ds_read_b64_tr_b16 v[92:93], v125 offset:26624
  ds_read_b64_tr_b16 v[94:95], v125 offset:27136
  v_mfma_f32_16x16x32_bf16 v[100:103], v[64:67], v[118:121], v[100:103]
  s_waitcnt lgkmcnt(4)
  v_mfma_f32_32x32x16_bf16 v[16:31], v[76:79], v[240:243], v[16:31]
  ds_read_b64_tr_b16 v[64:65], v124 offset:28672
  ds_read_b64_tr_b16 v[66:67], v124 offset:29184
  v_mfma_f32_32x32x16_bf16 v[32:47], v[80:83], v[240:243], v[32:47]
  ds_read_b64_tr_b16 v[68:69], v125 offset:28672
  ds_read_b64_tr_b16 v[70:71], v125 offset:29184
  v_mfma_f32_16x16x32_bf16 v[100:103], v[76:79], v[118:121], v[100:103]
  s_waitcnt lgkmcnt(4)
  v_mfma_f32_32x32x16_bf16 v[16:31], v[88:91], v[244:247], v[16:31]
  ds_read_b64_tr_b16 v[76:77], v124 offset:30720
  ds_read_b64_tr_b16 v[78:79], v124 offset:31232
  v_mfma_f32_32x32x16_bf16 v[32:47], v[92:95], v[244:247], v[32:47]
  ds_read_b64_tr_b16 v[80:81], v125 offset:30720
  ds_read_b64_tr_b16 v[82:83], v125 offset:31232
  v_mfma_f32_16x16x32_bf16 v[100:103], v[88:91], v[118:121], v[100:103]
  s_waitcnt lgkmcnt(4)
  v_mfma_f32_32x32x16_bf16 v[16:31], v[64:67], v[248:251], v[16:31]
  v_mfma_f32_32x32x16_bf16 v[32:47], v[68:71], v[248:251], v[32:47]
  v_mfma_f32_16x16x32_bf16 v[100:103], v[64:67], v[118:121], v[100:103]
  s_waitcnt lgkmcnt(0)
  v_mfma_f32_32x32x16_bf16 v[16:31], v[76:79], v[252:255], v[16:31]
  v_mfma_f32_32x32x16_bf16 v[32:47], v[80:83], v[252:255], v[32:47]
  v_mfma_f32_16x16x32_bf16 v[100:103], v[76:79], v[118:121], v[100:103]
  v_and_b32 v2, 15, v1
  v_lshrrev_b32 v3, 4, v1
  v_cmp_gt_u32 vcc, 2, v2
  v_lshlrev_b32 v2, 6, v2
  v_lshlrev_b32 v3, 4, v3
  v_add_u32 v2, v2, v3
  s_and_b32 s40, s33, 1
  s_lshl_b32 s40, s40, 7
  s_add_u32 s40, s40, 157184
  v_add_u32 v2, s40, v2
  s_and_saveexec_b64 s[60:61], vcc
  ds_write_b128 v2, v[100:103]
  s_mov_b64 exec, s[60:61]
  v_mov_b32 v4, 157688
  v_mov_b32 v5, 1
  s_waitcnt lgkmcnt(0)
  s_mov_b64 exec, 1
  ds_add_u32 v4, v5
  s_mov_b64 exec, -1
  s_mov_b32 s3, 0
L_cnt_10:
  s_add_u32 s3, s3, 1
  s_cmp_gt_u32 s3, 20000
  s_cbranch_scc1 L_cnt_10x
  ds_read_b32 v5, v4
  s_waitcnt lgkmcnt(0)
  v_cmp_gt_u32 vcc, 4, v5
  s_nop 0
  s_cbranch_vccnz L_cnt_10
L_cnt_10x:
  v_and_b32 v2, 31, v1
  v_lshlrev_b32 v2, 2, v2
  s_lshl_b32 s40, s33, 7
  s_add_u32 s40, s40, 155648
  v_add_u32 v2, s40, v2
  ds_read_b32 v122, v2
  ds_read_b32 v123, v2 offset:512
  v_lshrrev_b32 v3, 5, v1
  v_lshlrev_b32 v3, 4, v3
  v_add_u32 v3, 157184, v3
  s_and_b32 s40, s33, 1
  s_lshl_b32 s40, s40, 7
  v_add_u32 v170, s40, v3
  v_xor_b32 v171, 128, v170
  ds_read_b128 v[128:131], v170 offset:0
  ds_read_b128 v[132:135], v170 offset:32
  ds_read_b128 v[136:139], v170 offset:64
  ds_read_b128 v[140:143], v170 offset:96
  ds_read_b128 v[144:147], v171 offset:0
  ds_read_b128 v[148:151], v171 offset:32
  ds_read_b128 v[152:155], v171 offset:64
  ds_read_b128 v[156:159], v171 offset:96
  s_waitcnt lgkmcnt(4)
  v_mul_f32 v160, v123, v128
  v_mul_f32 v161, v123, v129
  v_mul_f32 v162, v123, v130
  v_mul_f32 v163, v123, v131
  v_mul_f32 v164, v123, v132
  v_mul_f32 v165, v123, v133
  v_mul_f32 v166, v123, v134
  v_mul_f32 v167, v123, v135
  v_fma_f32 v16, v16, v122, v160
  v_fma_f32 v17, v17, v122, v161
  v_fma_f32 v18, v18, v122, v162
  v_fma_f32 v19, v19, v122, v163
  v_fma_f32 v20, v20, v122, v164
  v_fma_f32 v21, v21, v122, v165
  v_fma_f32 v22, v22, v122, v166
  v_fma_f32 v23, v23, v122, v167
  v_min_f32 v160, 0, v16
  v_min_f32 v161, 0, v17
  v_min_f32 v162, 0, v18
  v_min_f32 v163, 0, v19
  v_min_f32 v164, 0, v20
  v_min_f32 v165, 0, v21
  v_min_f32 v166, 0, v22
  v_min_f32 v167, 0, v23
  v_exp_f32 v160, v160
  v_exp_f32 v161, v161
  v_exp_f32 v162, v162
  v_exp_f32 v163, v163
  v_exp_f32 v164, v164
  v_exp_f32 v165, v165
  v_exp_f32 v166, v166
  v_exp_f32 v167, v167
  v_max_f32 v16, s71, v16
  v_max_f32 v17, s71, v17
  v_max_f32 v18, s71, v18
  v_max_f32 v19, s71, v19
  v_max_f32 v20, s71, v20
  v_max_f32 v21, s71, v21
  v_max_f32 v22, s71, v22
  v_max_f32 v23, s71, v23
  v_fma_f32 v16, v16, s70, v160
  v_fma_f32 v17, v17, s70, v161
  v_fma_f32 v18, v18, s70, v162
  v_fma_f32 v19, v19, s70, v163
  v_fma_f32 v20, v20, s70, v164
  v_fma_f32 v21, v21, s70, v165
  v_fma_f32 v22, v22, s70, v166
  v_fma_f32 v23, v23, s70, v167
  v_cvt_pk_bf16_f32 v224, v16, v17
  v_cvt_pk_bf16_f32 v225, v18, v19
  v_cvt_pk_bf16_f32 v226, v20, v21
  v_cvt_pk_bf16_f32 v227, v22, v23
  v_mul_f32 v160, v123, v136
  v_mul_f32 v161, v123, v137
  v_mul_f32 v162, v123, v138
  v_mul_f32 v163, v123, v139
  v_mul_f32 v164, v123, v140
  v_mul_f32 v165, v123, v141
  v_mul_f32 v166, v123, v142
  v_mul_f32 v167, v123, v143
  v_fma_f32 v24, v24, v122, v160
  v_fma_f32 v25, v25, v122, v161
  v_fma_f32 v26, v26, v122, v162
  v_fma_f32 v27, v27, v122, v163
  v_fma_f32 v28, v28, v122, v164
  v_fma_f32 v29, v29, v122, v165
  v_fma_f32 v30, v30, v122, v166
  v_fma_f32 v31, v31, v122, v167
  v_min_f32 v160, 0, v24
  v_min_f32 v161, 0, v25
  v_min_f32 v162, 0, v26
  v_min_f32 v163, 0, v27
  v_min_f32 v164, 0, v28
  v_min_f32 v165, 0, v29
  v_min_f32 v166, 0, v30
  v_min_f32 v167, 0, v31
  v_exp_f32 v160, v160
  v_exp_f32 v161, v161
  v_exp_f32 v162, v162
  v_exp_f32 v163, v163
  v_exp_f32 v164, v164
  v_exp_f32 v165, v165
  v_exp_f32 v166, v166
  v_exp_f32 v167, v167
  v_max_f32 v24, s71, v24
  v_max_f32 v25, s71, v25
  v_max_f32 v26, s71, v26
  v_max_f32 v27, s71, v27
  v_max_f32 v28, s71, v28
  v_max_f32 v29, s71, v29
  v_max_f32 v30, s71, v30
  v_max_f32 v31, s71, v31
  v_fma_f32 v24, v24, s70, v160
  v_fma_f32 v25, v25, s70, v161
  v_fma_f32 v26, v26, s70, v162
  v_fma_f32 v27, v27, s70, v163
  v_fma_f32 v28, v28, s70, v164
  v_fma_f32 v29, v29, s70, v165
  v_fma_f32 v30, v30, s70, v166
  v_fma_f32 v31, v31, s70, v167
  v_cvt_pk_bf16_f32 v228, v24, v25
  v_cvt_pk_bf16_f32 v229, v26, v27
  v_cvt_pk_bf16_f32 v230, v28, v29
  v_cvt_pk_bf16_f32 v231, v30, v31
  s_waitcnt lgkmcnt(0)
  v_mul_f32 v160, v123, v144
  v_mul_f32 v161, v123, v145
  v_mul_f32 v162, v123, v146
  v_mul_f32 v163, v123, v147
  v_mul_f32 v164, v123, v148
  v_mul_f32 v165, v123, v149
  v_mul_f32 v166, v123, v150
  v_mul_f32 v167, v123, v151
  v_fma_f32 v32, v32, v122, v160
  v_fma_f32 v33, v33, v122, v161
  v_fma_f32 v34, v34, v122, v162
  v_fma_f32 v35, v35, v122, v163
  v_fma_f32 v36, v36, v122, v164
  v_fma_f32 v37, v37, v122, v165
  v_fma_f32 v38, v38, v122, v166
  v_fma_f32 v39, v39, v122, v167
  v_min_f32 v160, 0, v32
  v_min_f32 v161, 0, v33
  v_min_f32 v162, 0, v34
  v_min_f32 v163, 0, v35
  v_min_f32 v164, 0, v36
  v_min_f32 v165, 0, v37
  v_min_f32 v166, 0, v38
  v_min_f32 v167, 0, v39
  v_exp_f32 v160, v160
  v_exp_f32 v161, v161
  v_exp_f32 v162, v162
  v_exp_f32 v163, v163
  v_exp_f32 v164, v164
  v_exp_f32 v165, v165
  v_exp_f32 v166, v166
  v_exp_f32 v167, v167
  v_max_f32 v32, s71, v32
  v_max_f32 v33, s71, v33
  v_max_f32 v34, s71, v34
  v_max_f32 v35, s71, v35
  v_max_f32 v36, s71, v36
  v_max_f32 v37, s71, v37
  v_max_f32 v38, s71, v38
  v_max_f32 v39, s71, v39
  v_fma_f32 v32, v32, s70, v160
  v_fma_f32 v33, v33, s70, v161
  v_fma_f32 v34, v34, s70, v162
  v_fma_f32 v35, v35, s70, v163
  v_fma_f32 v36, v36, s70, v164
  v_fma_f32 v37, v37, s70, v165
  v_fma_f32 v38, v38, s70, v166
  v_fma_f32 v39, v39, s70, v167
  v_cvt_pk_bf16_f32 v232, v32, v33
  v_cvt_pk_bf16_f32 v233, v34, v35
  v_cvt_pk_bf16_f32 v234, v36, v37
  v_cvt_pk_bf16_f32 v235, v38, v39
  v_mul_f32 v160, v123, v152
  v_mul_f32 v161, v123, v153
  v_mul_f32 v162, v123, v154
  v_mul_f32 v163, v123, v155
  v_mul_f32 v164, v123, v156
  v_mul_f32 v165, v123, v157
  v_mul_f32 v166, v123, v158
  v_mul_f32 v167, v123, v159
  v_fma_f32 v40, v40, v122, v160
  v_fma_f32 v41, v41, v122, v161
  v_fma_f32 v42, v42, v122, v162
  v_fma_f32 v43, v43, v122, v163
  v_fma_f32 v44, v44, v122, v164
  v_fma_f32 v45, v45, v122, v165
  v_fma_f32 v46, v46, v122, v166
  v_fma_f32 v47, v47, v122, v167
  v_min_f32 v160, 0, v40
  v_min_f32 v161, 0, v41
  v_min_f32 v162, 0, v42
  v_min_f32 v163, 0, v43
  v_min_f32 v164, 0, v44
  v_min_f32 v165, 0, v45
  v_min_f32 v166, 0, v46
  v_min_f32 v167, 0, v47
  v_exp_f32 v160, v160
  v_exp_f32 v161, v161
  v_exp_f32 v162, v162
  v_exp_f32 v163, v163
  v_exp_f32 v164, v164
  v_exp_f32 v165, v165
  v_exp_f32 v166, v166
  v_exp_f32 v167, v167
  v_max_f32 v40, s71, v40
  v_max_f32 v41, s71, v41
  v_max_f32 v42, s71, v42
  v_max_f32 v43, s71, v43
  v_max_f32 v44, s71, v44
  v_max_f32 v45, s71, v45
  v_max_f32 v46, s71, v46
  v_max_f32 v47, s71, v47
  v_fma_f32 v40, v40, s70, v160
  v_fma_f32 v41, v41, s70, v161
  v_fma_f32 v42, v42, s70, v162
  v_fma_f32 v43, v43, s70, v163
  v_fma_f32 v44, v44, s70, v164
  v_fma_f32 v45, v45, s70, v165
  v_fma_f32 v46, v46, s70, v166
  v_fma_f32 v47, v47, s70, v167
  v_cvt_pk_bf16_f32 v236, v40, v41
  v_cvt_pk_bf16_f32 v237, v42, v43
  v_cvt_pk_bf16_f32 v238, v44, v45
  v_cvt_pk_bf16_f32 v239, v46, v47
  v_and_b32 v2, 31, v1
  v_lshrrev_b32 v3, 5, v1
  v_lshlrev_b32 v4, 5, v3
  v_add_u32 v4, v4, v2
  v_lshlrev_b32 v4, 2, v4
  v_lshlrev_b32 v5, 2, v3
  v_add_u32 v5, 256, v5
  v_cmp_gt_u32 vcc, 16, v2
  s_nop 1
  v_cndmask_b32 v216, v5, v4, vcc
  v_add_u32 v4, 64, v4
  v_add_u32 v5, 8, v5
  v_cndmask_b32 v217, v5, v4, vcc
  v_lshlrev_b32 v218, 4, v1
  s_and_b32 s41, s33, 1
  s_mul_i32 s42, s41, 2560
  s_add_u32 s60, s42, 158720
  s_xor_b32 s41, s41, 1
  s_mul_i32 s42, s41, 2560
  s_add_u32 s61, s42, 158720
  s_lshl_b32 s40, s35, 1
  s_and_b32 s41, s33, 1
  s_add_u32 s40, s40, s41
  s_lshl_b32 s40, s40, 12
  s_add_u32 s40, s40, 65536
  s_lshr_b32 s42, s33, 1
  s_lshl_b32 s43, s42, 10
  s_add_u32 s43, s43, s40
  s_add_u32 s40, s43, 2048
  s_mov_b32 s72, s43
  s_mov_b32 s75, s40
  s_mul_i32 s44, s42, 1280
  s_add_u32 s44, s44, s60
  v_lshrrev_b32 v2, 4, v1
  v_mul_u32_u24 v2, 320, v2
  v_and_b32 v3, 15, v1
  v_lshlrev_b32 v3, 4, v3
  v_add_u32 v2, v2, v3
  v_add_u32 v219, s44, v2
  v_and_b32 v2, 3, v1
  v_mul_u32_u24 v3, 320, v2
  v_add_u32 v3, 256, v3
  v_add_u32 v7, s44, v3
  v_lshlrev_b32 v6, 8, v2
  s_lshl_b32 s44, s34, 2
  s_add_u32 s44, s44, s33
  s_lshl_b32 s44, s44, 5
  s_lshl_b32 s45, s35, 2
  s_add_u32 s44, s44, s45
  s_lshl_b32 s44, s44, 10
  s_add_u32 s55, s44, 9437184
  s_and_b32 s41, s33, 1
  s_lshl_b32 s41, s41, 11
  s_add_u32 s62, s55, s41
  s_xor_b32 s41, s41, 2048
  s_add_u32 s63, s55, s41
  s_lshl_b32 s40, s35, 8
  s_add_u32 s40, s40, 12288
  v_and_b32 v2, 1, v1
  v_lshlrev_b32 v2, 7, v2
  s_mov_b32 s3, 0
L_c2_11:
  s_add_u32 s3, s3, 1
  s_cmp_gt_u32 s3, 20000
  s_cbranch_scc1 L_c2_11x
  buffer_load_dword v3, v2, s[12:15], s40 offen sc1
  s_waitcnt vmcnt(0)
  v_cmp_ne_u32 vcc, 32, v3
  s_nop 0
  s_cbranch_vccz L_c2_11x
  s_sleep 4
  s_branch L_c2_11
L_c2_11x:
  s_setprio 2
  buffer_load_dwordx4 v[128:131], v218, s[12:15], s72 offen sc1
  s_mov_b64 exec, 0xf
  buffer_load_dwordx4 v[132:135], v6, s[12:15], s75 offen sc1
  s_mov_b64 exec, -1
  s_waitcnt vmcnt(0)
  ds_write_b128 v219, v[128:131]
  s_mov_b64 exec, 0xf
  ds_write_b128 v7, v[132:135]
  s_mov_b64 exec, -1
  v_mov_b32 v2, 157692
  v_mov_b32 v3, 1
  s_waitcnt lgkmcnt(0)
  s_mov_b64 exec, 1
  ds_add_u32 v2, v3
  s_mov_b64 exec, -1
  v_mov_b32 v2, 157692
  s_mov_b32 s3, 0
L_cw_12:
  ds_read_b32 v3, v2
  s_waitcnt lgkmcnt(0)
  v_readfirstlane_b32 s43, v3
  s_nop 0
  s_cmp_ge_u32 s43, 4
  s_cbranch_scc1 L_cw_12x
  s_sleep 1
  s_add_u32 s3, s3, 1
  s_cmp_gt_u32 s3, 160000
  s_cbranch_scc0 L_cw_12
L_cw_12x:
  v_add_u32 v2, s60, v216
  ds_read_b32 v128, v2 offset:0
  ds_read_b32 v129, v2 offset:320
  ds_read_b32 v130, v2 offset:640
  ds_read_b32 v131, v2 offset:960
  ds_read_b32 v132, v2 offset:1280
  ds_read_b32 v133, v2 offset:1600
  ds_read_b32 v134, v2 offset:1920
  ds_read_b32 v135, v2 offset:2240
  v_add_u32 v2, s60, v217
  ds_read_b32 v136, v2 offset:0
  ds_read_b32 v137, v2 offset:320
  ds_read_b32 v138, v2 offset:640
  ds_read_b32 v139, v2 offset:960
  ds_read_b32 v140, v2 offset:1280
  ds_read_b32 v141, v2 offset:1600
  ds_read_b32 v142, v2 offset:1920
  ds_read_b32 v143, v2 offset:2240
  v_add_u32 v2, s61, v216
  ds_read_b32 v144, v2 offset:0
  ds_read_b32 v145, v2 offset:320
  ds_read_b32 v146, v2 offset:640
  ds_read_b32 v147, v2 offset:960
  ds_read_b32 v148, v2 offset:1280
  ds_read_b32 v149, v2 offset:1600
  ds_read_b32 v150, v2 offset:1920
  ds_read_b32 v151, v2 offset:2240
  v_add_u32 v2, s61, v217
  ds_read_b32 v152, v2 offset:0
  ds_read_b32 v153, v2 offset:320
  ds_read_b32 v154, v2 offset:640
  ds_read_b32 v155, v2 offset:960
  ds_read_b32 v156, v2 offset:1280
  ds_read_b32 v157, v2 offset:1600
  ds_read_b32 v158, v2 offset:1920
  ds_read_b32 v159, v2 offset:2240
  s_waitcnt lgkmcnt(15)
  v_cvt_pk_bf16_f32 v160, v128, v129
  v_cvt_pk_bf16_f32 v161, v130, v131
  v_cvt_pk_bf16_f32 v162, v132, v133
  v_cvt_pk_bf16_f32 v163, v134, v135
  s_nop 1
  v_mfma_f32_32x32x16_bf16 v[176:191], v[160:163], v[224:227], 0
  s_waitcnt lgkmcnt(15)
  v_cvt_pk_bf16_f32 v164, v136, v137
  v_cvt_pk_bf16_f32 v165, v138, v139
  v_cvt_pk_bf16_f32 v166, v140, v141
  v_cvt_pk_bf16_f32 v167, v142, v143
  s_nop 1
  v_mfma_f32_32x32x16_bf16 v[192:207], v[164:167], v[228:231], 0
  s_nop 3
  v_add_f32 v184, 0x358637bd, v184
  v_rcp_f32 v184, v184
  s_nop 0
  v_mul_f32 v176, v176, v184
  v_mul_f32 v177, v177, v184
  v_mul_f32 v178, v178, v184
  v_mul_f32 v179, v179, v184
  v_mul_f32 v180, v180, v184
  v_mul_f32 v181, v181, v184
  v_mul_f32 v182, v182, v184
  v_mul_f32 v183, v183, v184
  v_cvt_pk_bf16_f32 v208, v176, v177
  v_cvt_pk_bf16_f32 v209, v178, v179
  v_cvt_pk_bf16_f32 v210, v180, v181
  v_cvt_pk_bf16_f32 v211, v182, v183
  s_add_u32 s45, s62, 0
  buffer_store_dwordx4 v[208:211], v218, s[12:15], s45 offen sc1
  s_waitcnt lgkmcnt(8)
  v_cvt_pk_bf16_f32 v168, v144, v145
  v_cvt_pk_bf16_f32 v169, v146, v147
  v_cvt_pk_bf16_f32 v170, v148, v149
  v_cvt_pk_bf16_f32 v171, v150, v151
  s_nop 1
  v_mfma_f32_32x32x16_bf16 v[176:191], v[168:171], v[232:235], 0
  v_add_f32 v200, 0x358637bd, v200
  v_rcp_f32 v200, v200
  s_nop 0
  v_mul_f32 v192, v192, v200
  v_mul_f32 v193, v193, v200
  v_mul_f32 v194, v194, v200
  v_mul_f32 v195, v195, v200
  v_mul_f32 v196, v196, v200
  v_mul_f32 v197, v197, v200
  v_mul_f32 v198, v198, v200
  v_mul_f32 v199, v199, v200
  v_cvt_pk_bf16_f32 v212, v192, v193
  v_cvt_pk_bf16_f32 v213, v194, v195
  v_cvt_pk_bf16_f32 v214, v196, v197
  v_cvt_pk_bf16_f32 v215, v198, v199
  s_add_u32 s45, s62, 1024
  buffer_store_dwordx4 v[212:215], v218, s[12:15], s45 offen sc1
  s_waitcnt lgkmcnt(0)
  v_cvt_pk_bf16_f32 v172, v152, v153
  v_cvt_pk_bf16_f32 v173, v154, v155
  v_cvt_pk_bf16_f32 v174, v156, v157
  v_cvt_pk_bf16_f32 v175, v158, v159
  s_nop 1
  v_mfma_f32_32x32x16_bf16 v[192:207], v[172:175], v[236:239], 0
  v_add_f32 v184, 0x358637bd, v184
  v_rcp_f32 v184, v184
  s_nop 0
  v_mul_f32 v176, v176, v184
  v_mul_f32 v177, v177, v184
  v_mul_f32 v178, v178, v184
  v_mul_f32 v179, v179, v184
  v_mul_f32 v180, v180, v184
  v_mul_f32 v181, v181, v184
  v_mul_f32 v182, v182, v184
  v_mul_f32 v183, v183, v184
  v_cvt_pk_bf16_f32 v208, v176, v177
  v_cvt_pk_bf16_f32 v209, v178, v179
  v_cvt_pk_bf16_f32 v210, v180, v181
  v_cvt_pk_bf16_f32 v211, v182, v183
  s_add_u32 s45, s63, 0
  buffer_store_dwordx4 v[208:211], v218, s[12:15], s45 offen sc1
  v_add_f32 v200, 0x358637bd, v200
  v_rcp_f32 v200, v200
  s_nop 0
  v_mul_f32 v192, v192, v200
  v_mul_f32 v193, v193, v200
  v_mul_f32 v194, v194, v200
  v_mul_f32 v195, v195, v200
  v_mul_f32 v196, v196, v200
  v_mul_f32 v197, v197, v200
  v_mul_f32 v198, v198, v200
  v_mul_f32 v199, v199, v200
  v_cvt_pk_bf16_f32 v212, v192, v193
  v_cvt_pk_bf16_f32 v213, v194, v195
  v_cvt_pk_bf16_f32 v214, v196, v197
  v_cvt_pk_bf16_f32 v215, v198, v199
  s_add_u32 s45, s63, 1024
  buffer_store_dwordx4 v[212:215], v218, s[12:15], s45 offen sc1
  s_waitcnt vmcnt(0)
  s_lshl_b32 s42, s34, 1
  s_lshr_b32 s43, s33, 1
  s_add_u32 s42, s42, s43
  s_lshl_b32 s42, s42, 7
  s_lshl_b32 s43, s35, 1
  s_and_b32 s44, s33, 1
  s_add_u32 s43, s43, s44
  s_lshl_b32 s43, s43, 2
  s_add_u32 s40, s42, s43
  s_add_u32 s40, s40, 8192
  v_mov_b32 v2, 0
  v_mov_b32 v3, s1
  s_mov_b64 exec, 1
  buffer_store_dword v3, v2, s[12:15], s40 offen sc1
  s_mov_b64 exec, -1
  s_endpgm
L_Bend1:
L_A:
  s_mov_b32 s12, s92
  s_mov_b32 s13, s93
  s_mov_b32 s14, 16777216
  s_mov_b32 s15, 0x20000
  s_mov_b32 s16, s86
  s_mov_b32 s17, s87
  s_mov_b32 s18, 1835008
  s_mov_b32 s19, 0x20000
  s_mov_b32 s20, s80
  s_mov_b32 s21, s81
  s_mov_b32 s22, 524288
  s_mov_b32 s23, 0x20000
  s_mov_b32 s24, s88
  s_mov_b32 s25, s89
  s_mov_b32 s26, 2097152
  s_mov_b32 s27, 0x20000
  s_mov_b32 s28, s90
  s_mov_b32 s29, s91
  s_mov_b32 s30, 256
  s_mov_b32 s31, 0x20000
  s_mov_b32 s70, 0x3f317218
  s_mov_b32 s71, 0x35c1a2a0
  s_lshl_b32 s40, s36, 3
  s_add_u32 s40, s40, s35
  s_lshl_b32 s40, s40, 3
  s_lshl_b32 s41, s33, 1
  s_add_u32 s40, s40, s41
  s_lshl_b32 s41, s34, 7
  s_add_u32 s72, s40, s41
  s_lshl_b32 s40, s72, 10
  v_lshlrev_b32 v2, 4, v1
  buffer_load_dwordx4 v[40:43], v2, s[4:7], s40 offen
  buffer_load_dwordx4 v[44:47], v2, s[4:7], s40 offen offset:1024
  s_cmp_ge_u32 s2, 8
  s_cbranch_scc1 L_nz_13
  s_or_b32 s40, s2, s33
  s_cmp_lg_u32 s40, 0
  s_cbranch_scc1 L_nn_14
  s_load_dword s43, s[92:93], 16384 glc
L_nn_14:
  v_mov_b32 v8, 0
  v_mov_b32 v9, 0
  v_mov_b32 v10, 0
  v_mov_b32 v11, 0
  v_lshlrev_b32 v2, 4, v1
  s_lshl_b32 s40, s2, 13
  s_lshl_b32 s41, s33, 11
  s_add_u32 s40, s40, s41
  s_add_u32 s40, s40, 65536
  buffer_store_dwordx4 v[8:11], v2, s[12:15], s40 offen sc1
  buffer_store_dwordx4 v[8:11], v2, s[12:15], s40 offen offset:1024 sc1
  s_lshl_b32 s40, s2, 8
  s_add_u32 s40, s40, 12288
  s_mov_b64 exec, 0xffff
  buffer_store_dwordx4 v[8:11], v2, s[12:15], s40 offen sc1
  s_mov_b64 exec, -1
  s_or_b32 s40, s2, s33
  s_cmp_lg_u32 s40, 0
  s_cbranch_scc1 L_nn_15
  s_waitcnt lgkmcnt(0)
  s_add_u32 s43, s43, 1
  s_or_b32 s43, s43, 1
  v_mov_b32 v3, s43
  v_mov_b32 v4, 128
  v_mov_b32 v5, 16384
  s_mov_b64 exec, 1
  buffer_store_dword v3, v4, s[28:31], 0 offen sc1
  buffer_store_dword v3, v5, s[12:15], 0 offen sc1
  s_mov_b64 exec, -1
L_nn_15:
  s_lshl_b32 s40, s2, 2
  s_add_u32 s40, s40, s33
  s_lshl_b32 s40, s40, 2
  v_mov_b32 v2, s40
  v_mov_b32 v3, 1
  s_waitcnt vmcnt(0)
  s_mov_b64 exec, 1
  buffer_store_dword v3, v2, s[28:31], 0 offen sc1
  s_mov_b64 exec, -1
L_nz_13:
  s_and_b32 s40, s2, 7
  s_lshr_b32 s41, s2, 3
  s_lshr_b32 s42, s40, 1
  s_lshl_b32 s42, s42, 3
  s_and_b32 s43, s41, 7
  s_add_u32 s62, s42, s43
  s_and_b32 s42, s40, 1
  s_lshl_b32 s42, s42, 2
  s_lshr_b32 s43, s41, 3
  s_add_u32 s63, s42, s43
  s_lshr_b32 s40, s33, 1
  s_lshl_b32 s41, s62, 1
  s_add_u32 s42, s41, s40
  s_xor_b32 s43, s42, 1
  s_mul_i32 s44, s33, 28
  s_mul_i32 s45, s42, 112
  s_add_u32 s45, s45, s44
  s_lshl_b32 s45, s45, 10
  s_add_u32 s64, s45, 1048576
  s_mul_i32 s45, s43, 112
  s_add_u32 s45, s45, s44
  s_lshl_b32 s45, s45, 10
  s_add_u32 s65, s45, 1048576
  s_lshl_b32 s44, s33, 3
  s_lshl_b32 s45, s42, 5
  s_add_u32 s45, s45, s44
  s_lshl_b32 s45, s45, 10
  s_add_u32 s68, s45, 9437184
  s_lshl_b32 s45, s43, 5
  s_add_u32 s45, s45, s44
  s_lshl_b32 s45, s45, 10
  s_add_u32 s69, s45, 9437184
  s_lshl_b32 s40, s63, 7
  s_mul_i32 s41, s33, 458752
  s_add_u32 s66, s40, s41
  s_lshl_b32 s41, s33, 17
  s_add_u32 s39, s40, s41
  s_mul_i32 s67, s33, 14336
  s_add_u32 s67, s67, 98304
  v_lshlrev_b32 v250, 4, v1
  v_lshrrev_b32 v2, 3, v1
  v_lshlrev_b32 v2, 10, v2
  v_and_b32 v3, 7, v1
  v_lshrrev_b32 v4, 4, v1
  v_and_b32 v4, 1, v4
  v_lshlrev_b32 v4, 2, v4
  v_xor_b32 v3, v3, v4
  v_lshlrev_b32 v3, 4, v3
  v_add_u32 v251, v2, v3
  v_add_u32 v249, 7168, v251
  v_lshrrev_b32 v2, 5, v1
  v_lshlrev_b32 v2, 2, v2
  v_and_b32 v3, 15, v1
  v_lshrrev_b32 v4, 2, v3
  v_add_u32 v2, v2, v4
  v_lshlrev_b32 v2, 7, v2
  v_lshrrev_b32 v4, 3, v3
  v_lshlrev_b32 v4, 6, v4
  v_add_u32 v2, v2, v4
  v_lshrrev_b32 v4, 4, v1
  v_and_b32 v4, 1, v4
  v_lshlrev_b32 v4, 5, v4
  v_add_u32 v2, v2, v4
  v_and_b32 v4, 3, v3
  v_lshlrev_b32 v4, 3, v4
  v_add_u32 v2, v2, v4
  s_and_b32 s40, s33, 1
  s_lshl_b32 s40, s40, 6
  v_xor_b32 v2, s40, v2
  v_add_u32 v252, s67, v2
  v_xor_b32 v253, 64, v252
  s_mul_i32 s96, s33, 12288
  s_add_u32 s96, s96, 49152
  v_mov_b32 v248, v2
  s_and_b32 s0, s62, 1
  s_lshl_b32 s0, s0, 1
  s_and_b32 s98, s63, 3
  s_mov_b32 s76, 0
  s_and_b32 s43, s76, 1
  s_lshl_b32 s43, s43, 2
  s_and_b32 s76, s76, 2
  s_mul_i32 s76, s76, 10
  s_add_u32 s76, s76, s43
  s_mov_b32 s44, s0
  s_add_u32 s76, s76, s44
  s_mov_b32 s77, 1
  s_and_b32 s43, s77, 1
  s_lshl_b32 s43, s43, 2
  s_and_b32 s77, s77, 2
  s_mul_i32 s77, s77, 10
  s_add_u32 s77, s77, s43
  s_mov_b32 s44, s0
  s_add_u32 s77, s77, s44
  s_mov_b32 s78, 2
  s_and_b32 s43, s78, 1
  s_lshl_b32 s43, s43, 2
  s_and_b32 s78, s78, 2
  s_mul_i32 s78, s78, 10
  s_add_u32 s78, s78, s43
  s_mov_b32 s44, s0
  s_add_u32 s78, s78, s44
  s_mov_b32 s79, 3
  s_and_b32 s43, s79, 1
  s_lshl_b32 s43, s43, 2
  s_and_b32 s79, s79, 2
  s_mul_i32 s79, s79, 10
  s_add_u32 s79, s79, s43
  s_mov_b32 s44, s0
  s_add_u32 s79, s79, s44
  s_lshl_b32 s73, s76, 14
  s_add_u32 s73, s73, s66
  s_lshl_b32 s74, s77, 14
  s_add_u32 s74, s74, s66
  s_lshl_b32 s75, s78, 14
  s_add_u32 s75, s75, s66
  s_lshl_b32 s97, s79, 14
  s_add_u32 s97, s97, s66
  s_lshl_b32 s43, s76, 10
  s_add_u32 s46, s43, s64
  s_add_u32 s47, s43, s65
  s_lshl_b32 s43, s77, 10
  s_add_u32 s48, s43, s64
  s_add_u32 s49, s43, s65
  s_lshl_b32 s43, s78, 10
  s_add_u32 s50, s43, s64
  s_add_u32 s51, s43, s65
  s_lshl_b32 s43, s79, 10
  s_add_u32 s52, s43, s64
  s_add_u32 s53, s43, s65
  v_and_b32 v2, 31, v1
  v_lshlrev_b32 v2, 10, v2
  v_lshrrev_b32 v3, 5, v1
  v_lshlrev_b32 v3, 4, v3
  v_add_u32 v254, v2, v3
  s_cmp_eq_u32 s36, 0
  s_cbranch_scc0 L_AQ
  s_and_b32 s40, s33, 1
  s_lshr_b32 s41, s33, 1
  v_and_b32 v2, 31, v1
  v_lshrrev_b32 v3, 5, v1
  v_lshrrev_b32 v4, 1, v2
  v_and_b32 v4, 7, v4
  v_xor_b32 v4, v4, v3
  v_lshlrev_b32 v4, 4, v4
  v_lshlrev_b32 v5, 7, v2
  v_add_u32 v4, v4, v5
  s_lshl_b32 s42, s40, 13
  v_add_u32 v4, s42, v4
  v_xor_b32 v124, 0, v4
  v_add_u32 v128, 65536, v124
  v_xor_b32 v125, 32, v4
  v_add_u32 v129, 65536, v125
  v_xor_b32 v126, 64, v4
  v_add_u32 v130, 65536, v126
  v_xor_b32 v127, 96, v4
  v_add_u32 v131, 65536, v127
  v_lshrrev_b32 v2, 5, v1
  v_lshlrev_b32 v2, 3, v2
  v_and_b32 v3, 15, v1
  v_lshrrev_b32 v4, 2, v3
  v_add_u32 v2, v2, v4
  v_lshlrev_b32 v2, 7, v2
  v_lshrrev_b32 v4, 3, v3
  v_lshlrev_b32 v4, 6, v4
  v_add_u32 v2, v2, v4
  v_lshrrev_b32 v4, 4, v1
  v_and_b32 v4, 1, v4
  v_lshlrev_b32 v4, 5, v4
  v_add_u32 v2, v2, v4
  v_and_b32 v4, 3, v3
  v_lshlrev_b32 v4, 3, v4
  v_add_u32 v2, v2, v4
  s_lshl_b32 s42, s40, 6
  v_xor_b32 v2, s42, v2
  s_lshl_b32 s42, s41, 13
  s_add_u32 s42, s42, 16384
  v_add_u32 v132, s42, v2
  v_xor_b32 v133, 64, v132
  v_add_u32 v134, 65536, v132
  v_add_u32 v135, 65536, v133
  v_and_b32 v2, 15, v1
  v_lshrrev_b32 v3, 4, v1
  v_and_b32 v3, 1, v3
  v_cmp_eq_u32 vcc, v2, v3
  v_mov_b32 v2, 0x3f803f80
  s_nop 0
  v_cndmask_b32 v120, 0, v2, vcc
  v_mov_b32 v121, v120
  v_mov_b32 v122, v120
  v_mov_b32 v123, v120
  s_cmp_ge_u32 s34, 8
  s_cselect_b32 s42, -1, 0
  v_and_b32 v236, s42, v120
  v_and_b32 v237, s42, v121
  v_and_b32 v238, s42, v122
  v_and_b32 v239, s42, v123
  s_not_b32 s42, s42
  v_and_b32 v120, s42, v120
  v_and_b32 v121, s42, v121
  v_and_b32 v122, s42, v122
  v_and_b32 v123, s42, v123
  v_mov_b32 v2, 157688
  v_mov_b32 v3, 0
  ds_write_b32 v2, v3
  ds_write_b32 v2, v3 offset:4
  v_mov_b32 v2, 157648
  v_mov_b32 v4, 0
  v_mov_b32 v5, 0
  v_mov_b32 v6, 0
  v_mov_b32 v7, 0
  ds_write_b128 v2, v[4:7]
  ds_write_b128 v2, v[4:7] offset:16
  s_waitcnt vmcnt(0)
  v_lshlrev_b32 v48, 16, v40
  v_and_b32 v49, 0xffff0000, v40
  v_add_f32 v50, v48, v49
  v_mul_f32 v51, v48, v48
  v_fmac_f32 v51, v49, v49
  v_lshlrev_b32 v48, 16, v41
  v_and_b32 v49, 0xffff0000, v41
  v_add_f32 v50, v50, v48
  v_fmac_f32 v51, v48, v48
  v_add_f32 v50, v50, v49
  v_fmac_f32 v51, v49, v49
  v_lshlrev_b32 v48, 16, v42
  v_and_b32 v49, 0xffff0000, v42
  v_add_f32 v50, v50, v48
  v_fmac_f32 v51, v48, v48
  v_add_f32 v50, v50, v49
  v_fmac_f32 v51, v49, v49
  v_lshlrev_b32 v48, 16, v43
  v_and_b32 v49, 0xffff0000, v43
  v_add_f32 v50, v50, v48
  v_fmac_f32 v51, v48, v48
  v_add_f32 v50, v50, v49
  v_fmac_f32 v51, v49, v49
  v_lshlrev_b32 v48, 16, v44
  v_and_b32 v49, 0xffff0000, v44
  v_add_f32 v52, v48, v49
  v_mul_f32 v53, v48, v48
  v_fmac_f32 v53, v49, v49
  v_lshlrev_b32 v48, 16, v45
  v_and_b32 v49, 0xffff0000, v45
  v_add_f32 v52, v52, v48
  v_fmac_f32 v53, v48, v48
  v_add_f32 v52, v52, v49
  v_fmac_f32 v53, v49, v49
  v_lshlrev_b32 v48, 16, v46
  v_and_b32 v49, 0xffff0000, v46
  v_add_f32 v52, v52, v48
  v_fmac_f32 v53, v48, v48
  v_add_f32 v52, v52, v49
  v_fmac_f32 v53, v49, v49
  v_lshlrev_b32 v48, 16, v47
  v_and_b32 v49, 0xffff0000, v47
  v_add_f32 v52, v52, v48
  v_fmac_f32 v53, v48, v48
  v_add_f32 v52, v52, v49
  v_fmac_f32 v53, v49, v49
  v_add_f32_dpp v50, v50, v50 row_shr:1 row_mask:0xf bank_mask:0xf bound_ctrl:0
  v_add_f32_dpp v51, v51, v51 row_shr:1 row_mask:0xf bank_mask:0xf bound_ctrl:0
  v_add_f32_dpp v52, v52, v52 row_shr:1 row_mask:0xf bank_mask:0xf bound_ctrl:0
  v_add_f32_dpp v53, v53, v53 row_shr:1 row_mask:0xf bank_mask:0xf bound_ctrl:0
  v_add_f32_dpp v50, v50, v50 row_shr:2 row_mask:0xf bank_mask:0xf bound_ctrl:0
  v_add_f32_dpp v51, v51, v51 row_shr:2 row_mask:0xf bank_mask:0xf bound_ctrl:0
  v_add_f32_dpp v52, v52, v52 row_shr:2 row_mask:0xf bank_mask:0xf bound_ctrl:0
  v_add_f32_dpp v53, v53, v53 row_shr:2 row_mask:0xf bank_mask:0xf bound_ctrl:0
  v_add_f32_dpp v50, v50, v50 row_shr:4 row_mask:0xf bank_mask:0xf bound_ctrl:0
  v_add_f32_dpp v51, v51, v51 row_shr:4 row_mask:0xf bank_mask:0xf bound_ctrl:0
  v_add_f32_dpp v52, v52, v52 row_shr:4 row_mask:0xf bank_mask:0xf bound_ctrl:0
  v_add_f32_dpp v53, v53, v53 row_shr:4 row_mask:0xf bank_mask:0xf bound_ctrl:0
  v_add_f32_dpp v50, v50, v50 row_shr:8 row_mask:0xf bank_mask:0xf bound_ctrl:0
  v_add_f32_dpp v51, v51, v51 row_shr:8 row_mask:0xf bank_mask:0xf bound_ctrl:0
  v_add_f32_dpp v52, v52, v52 row_shr:8 row_mask:0xf bank_mask:0xf bound_ctrl:0
  v_add_f32_dpp v53, v53, v53 row_shr:8 row_mask:0xf bank_mask:0xf bound_ctrl:0
  v_add_f32_dpp v50, v50, v50 row_bcast:15 row_mask:0xa bank_mask:0xf
  v_add_f32_dpp v51, v51, v51 row_bcast:15 row_mask:0xa bank_mask:0xf
  v_add_f32_dpp v52, v52, v52 row_bcast:15 row_mask:0xa bank_mask:0xf
  v_add_f32_dpp v53, v53, v53 row_bcast:15 row_mask:0xa bank_mask:0xf
  v_add_f32_dpp v50, v50, v50 row_bcast:31 row_mask:0xc bank_mask:0xf
  v_add_f32_dpp v51, v51, v51 row_bcast:31 row_mask:0xc bank_mask:0xf
  v_add_f32_dpp v52, v52, v52 row_bcast:31 row_mask:0xc bank_mask:0xf
  v_add_f32_dpp v53, v53, v53 row_bcast:31 row_mask:0xc bank_mask:0xf
  v_mul_f32 v50, 0x3b000000, v50
  v_mul_f32 v51, 0x3b000000, v51
  v_fma_f32 v51, -v50, v50, v51
  v_max_f32 v51, 0, v51
  v_add_f32 v51, 0x3727c5ac, v51
  v_rsq_f32 v51, v51
  s_nop 0
  v_mul_f32 v54, 0x3fb8aa3b, v51
  v_mul_f32 v55, v54, v50
  v_sub_f32 v55, 0, v55
  v_mul_f32 v52, 0x3b000000, v52
  v_mul_f32 v53, 0x3b000000, v53
  v_fma_f32 v53, -v52, v52, v53
  v_max_f32 v53, 0, v53
  v_add_f32 v53, 0x3727c5ac, v53
  v_rsq_f32 v53, v53
  s_nop 0
  v_mul_f32 v56, 0x3fb8aa3b, v53
  v_mul_f32 v57, v56, v52
  v_sub_f32 v57, 0, v57
  v_mov_b32 v2, 128
  s_mov_b32 s3, 0
L_gn_16:
  s_add_u32 s3, s3, 1
  s_cmp_gt_u32 s3, 20000
  s_cbranch_scc1 L_gn_16x
  buffer_load_dword v3, v2, s[28:31], 0 offen sc1
  s_waitcnt vmcnt(0)
  v_readfirstlane_b32 s1, v3
  s_nop 0
  s_cmp_eq_u32 s1, 0
  s_cbranch_scc1 L_gn_16
L_gn_16x:
  v_mov_b32 v2, 157680
  v_mov_b32 v3, s1
  ds_write_b32 v2, v3
  v_mov_b32 v60, v56
  v_mov_b32 v61, v57
  v_mov_b32 v56, s1
  v_mov_b32 v57, s1
  v_mov_b32 v62, s1
  v_mov_b32 v63, s1
  s_lshl_b32 s40, s72, 4
  s_add_u32 s40, s40, 196608
  v_mov_b32 v2, 0
  s_mov_b32 exec_lo, 0
  s_mov_b32 exec_hi, 0x80000000
  buffer_store_dwordx4 v[54:57], v2, s[12:15], s40 offen sc1
  buffer_store_dwordx4 v[60:63], v2, s[12:15], s40 offen offset:16 sc1
  s_mov_b64 exec, -1
  s_waitcnt lgkmcnt(0)
  s_barrier
  ds_read_b64_tr_b16 v[184:185], v132 offset:0
  ds_read_b64_tr_b16 v[186:187], v132 offset:512
  ds_read_b64_tr_b16 v[188:189], v133 offset:0
  ds_read_b64_tr_b16 v[190:191], v133 offset:512
  ds_read_b128 v[80:83], v124 offset:0
  ds_read_b128 v[84:87], v124 offset:4096
  ds_read_b64_tr_b16 v[192:193], v132 offset:2048
  ds_read_b64_tr_b16 v[194:195], v132 offset:2560
  ds_read_b64_tr_b16 v[196:197], v133 offset:2048
  ds_read_b64_tr_b16 v[198:199], v133 offset:2560
  ds_read_b128 v[88:91], v125 offset:0
  ds_read_b128 v[92:95], v125 offset:4096
  s_waitcnt lgkmcnt(6)
  v_mfma_f32_32x32x16_bf16 v[16:31], v[184:187], v[80:83], 0
  ds_read_b64_tr_b16 v[200:201], v132 offset:4096
  ds_read_b64_tr_b16 v[202:203], v132 offset:4608
  v_mfma_f32_32x32x16_bf16 v[32:47], v[188:191], v[80:83], 0
  ds_read_b64_tr_b16 v[204:205], v133 offset:4096
  ds_read_b64_tr_b16 v[206:207], v133 offset:4608
  v_mfma_f32_32x32x16_bf16 v[48:63], v[184:187], v[84:87], 0
  ds_read_b128 v[96:99], v126 offset:0
  ds_read_b128 v[100:103], v126 offset:4096
  v_mfma_f32_32x32x16_bf16 v[64:79], v[188:191], v[84:87], 0
  v_mfma_f32_16x16x32_bf16 v[112:115], v[184:187], v[120:123], 0
  s_waitcnt lgkmcnt(6)
  v_mfma_f32_32x32x16_bf16 v[16:31], v[192:195], v[88:91], v[16:31]
  ds_read_b64_tr_b16 v[184:185], v132 offset:6144
  ds_read_b64_tr_b16 v[186:187], v132 offset:6656
  v_mfma_f32_32x32x16_bf16 v[32:47], v[196:199], v[88:91], v[32:47]
  ds_read_b64_tr_b16 v[188:189], v133 offset:6144
  ds_read_b64_tr_b16 v[190:191], v133 offset:6656
  v_mfma_f32_32x32x16_bf16 v[48:63], v[192:195], v[92:95], v[48:63]
  ds_read_b128 v[80:83], v127 offset:0
  ds_read_b128 v[84:87], v127 offset:4096
  v_mfma_f32_32x32x16_bf16 v[64:79], v[196:199], v[92:95], v[64:79]
  v_mfma_f32_16x16x32_bf16 v[112:115], v[192:195], v[120:123], v[112:115]
  s_waitcnt lgkmcnt(0)
  v_mfma_f32_32x32x16_bf16 v[16:31], v[200:203], v[96:99], v[16:31]
  s_barrier
  ds_read_b64_tr_b16 v[192:193], v132 offset:32768
  ds_read_b64_tr_b16 v[194:195], v132 offset:33280
  v_mfma_f32_32x32x16_bf16 v[32:47], v[204:207], v[96:99], v[32:47]
  ds_read_b64_tr_b16 v[196:197], v133 offset:32768
  ds_read_b64_tr_b16 v[198:199], v133 offset:33280
  v_mfma_f32_32x32x16_bf16 v[48:63], v[200:203], v[100:103], v[48:63]
  ds_read_b128 v[88:91], v124 offset:32768
  ds_read_b128 v[92:95], v124 offset:36864
  v_mfma_f32_32x32x16_bf16 v[64:79], v[204:207], v[100:103], v[64:79]
  v_mfma_f32_16x16x32_bf16 v[112:115], v[200:203], v[236:239], v[112:115]
  s_waitcnt lgkmcnt(6)
  v_mfma_f32_32x32x16_bf16 v[16:31], v[184:187], v[80:83], v[16:31]
  ds_read_b64_tr_b16 v[200:201], v132 offset:34816
  ds_read_b64_tr_b16 v[202:203], v132 offset:35328
  v_mfma_f32_32x32x16_bf16 v[32:47], v[188:191], v[80:83], v[32:47]
  ds_read_b64_tr_b16 v[204:205], v133 offset:34816
  ds_read_b64_tr_b16 v[206:207], v133 offset:35328
  v_mfma_f32_32x32x16_bf16 v[48:63], v[184:187], v[84:87], v[48:63]
  ds_read_b128 v[96:99], v125 offset:32768
  ds_read_b128 v[100:103], v125 offset:36864
  v_mfma_f32_32x32x16_bf16 v[64:79], v[188:191], v[84:87], v[64:79]
  v_mfma_f32_16x16x32_bf16 v[112:115], v[184:187], v[236:239], v[112:115]
  s_waitcnt lgkmcnt(6)
  v_mfma_f32_32x32x16_bf16 v[16:31], v[192:195], v[88:91], v[16:31]
  s_and_b32 s40, s34, 7
  s_lshl_b32 s40, s40, 6
  s_lshl_b32 s41, s33, 4
  s_add_u32 s40, s40, s41
  s_mul_i32 s40, s40, s38
  s_lshl_b32 s41, s59, 1
  s_and_b32 s41, s41, 0xffffff80
  s_add_u32 s40, s40, s41
  v_lshrrev_b32 v2, 1, v1
  v_and_b32 v2, 15, v2
  v_mul_lo_u32 v2, v2, s38
  v_and_b32 v3, 1, v1
  v_lshlrev_b32 v3, 7, v3
  v_add_u32 v2, v2, v3
  s_mov_b32 exec_hi, 0
  buffer_load_dword v255, v2, s[8:11], s40 offen
  s_mov_b32 exec_hi, -1
  ds_read_b64_tr_b16 v[184:185], v132 offset:36864
  ds_read_b64_tr_b16 v[186:187], v132 offset:37376
  v_mfma_f32_32x32x16_bf16 v[32:47], v[196:199], v[88:91], v[32:47]
  ds_read_b64_tr_b16 v[188:189], v133 offset:36864
  ds_read_b64_tr_b16 v[190:191], v133 offset:37376
  v_mfma_f32_32x32x16_bf16 v[48:63], v[192:195], v[92:95], v[48:63]
  ds_read_b128 v[80:83], v126 offset:32768
  ds_read_b128 v[84:87], v126 offset:36864
  v_mfma_f32_32x32x16_bf16 v[64:79], v[196:199], v[92:95], v[64:79]
  s_waitcnt lgkmcnt(6)
  v_mfma_f32_32x32x16_bf16 v[16:31], v[200:203], v[96:99], v[16:31]
  v_and_b32 v2, 15, v1
  v_lshrrev_b32 v3, 4, v1
  v_cmp_gt_u32 vcc, 2, v2
  v_lshlrev_b32 v2, 6, v2
  v_lshlrev_b32 v3, 4, v3
  v_add_u32 v2, v2, v3
  s_lshl_b32 s40, s33, 7
  s_add_u32 s40, s40, 157696
  v_add_u32 v2, s40, v2
  s_and_saveexec_b64 s[60:61], vcc
  ds_write_b128 v2, v[112:115] offset:0
  s_mov_b64 exec, s[60:61]
  ds_read_b64_tr_b16 v[192:193], v132 offset:38912
  ds_read_b64_tr_b16 v[194:195], v132 offset:39424
  v_mfma_f32_32x32x16_bf16 v[32:47], v[204:207], v[96:99], v[32:47]
  ds_read_b64_tr_b16 v[196:197], v133 offset:38912
  ds_read_b64_tr_b16 v[198:199], v133 offset:39424
  v_mfma_f32_32x32x16_bf16 v[48:63], v[200:203], v[100:103], v[48:63]
  ds_read_b128 v[88:91], v127 offset:32768
  ds_read_b128 v[92:95], v127 offset:36864
  v_mfma_f32_32x32x16_bf16 v[64:79], v[204:207], v[100:103], v[64:79]
  s_waitcnt lgkmcnt(0)
  v_mfma_f32_32x32x16_bf16 v[16:31], v[184:187], v[80:83], v[16:31]
  s_barrier
  ds_read_b64_tr_b16 v[200:201], v134 offset:0
  ds_read_b64_tr_b16 v[202:203], v134 offset:512
  v_mfma_f32_32x32x16_bf16 v[32:47], v[188:191], v[80:83], v[32:47]
  ds_read_b64_tr_b16 v[204:205], v135 offset:0
  ds_read_b64_tr_b16 v[206:207], v135 offset:512
  v_mfma_f32_32x32x16_bf16 v[48:63], v[184:187], v[84:87], v[48:63]
  ds_read_b128 v[96:99], v128 offset:0
  ds_read_b128 v[100:103], v128 offset:4096
  v_mfma_f32_32x32x16_bf16 v[64:79], v[188:191], v[84:87], v[64:79]
  s_waitcnt lgkmcnt(6)
  v_mfma_f32_32x32x16_bf16 v[16:31], v[192:195], v[88:91], v[16:31]
  ds_read_b64_tr_b16 v[184:185], v134 offset:2048
  ds_read_b64_tr_b16 v[186:187], v134 offset:2560
  v_mfma_f32_32x32x16_bf16 v[32:47], v[196:199], v[88:91], v[32:47]
  ds_read_b64_tr_b16 v[188:189], v135 offset:2048
  ds_read_b64_tr_b16 v[190:191], v135 offset:2560
  v_mfma_f32_32x32x16_bf16 v[48:63], v[192:195], v[92:95], v[48:63]
  ds_read_b128 v[80:83], v129 offset:0
  ds_read_b128 v[84:87], v129 offset:4096
  v_mfma_f32_32x32x16_bf16 v[64:79], v[196:199], v[92:95], v[64:79]
  s_waitcnt lgkmcnt(6)
  v_mfma_f32_32x32x16_bf16 v[16:31], v[200:203], v[96:99], v[16:31]
  ds_read_b64_tr_b16 v[192:193], v134 offset:4096
  ds_read_b64_tr_b16 v[194:195], v134 offset:4608
  v_mfma_f32_32x32x16_bf16 v[32:47], v[204:207], v[96:99], v[32:47]
  ds_read_b64_tr_b16 v[196:197], v135 offset:4096
  ds_read_b64_tr_b16 v[198:199], v135 offset:4608
  v_mfma_f32_32x32x16_bf16 v[48:63], v[200:203], v[100:103], v[48:63]
  ds_read_b128 v[88:91], v130 offset:0
  ds_read_b128 v[92:95], v130 offset:4096
  v_mfma_f32_32x32x16_bf16 v[64:79], v[204:207], v[100:103], v[64:79]
  s_waitcnt lgkmcnt(6)
  v_mfma_f32_32x32x16_bf16 v[16:31], v[184:187], v[80:83], v[16:31]
  ds_read_b64_tr_b16 v[200:201], v134 offset:6144
  ds_read_b64_tr_b16 v[202:203], v134 offset:6656
  v_mfma_f32_32x32x16_bf16 v[32:47], v[188:191], v[80:83], v[32:47]
  ds_read_b64_tr_b16 v[204:205], v135 offset:6144
  ds_read_b64_tr_b16 v[206:207], v135 offset:6656
  v_mfma_f32_32x32x16_bf16 v[48:63], v[184:187], v[84:87], v[48:63]
  ds_read_b128 v[96:99], v131 offset:0
  ds_read_b128 v[100:103], v131 offset:4096
  v_mfma_f32_32x32x16_bf16 v[64:79], v[188:191], v[84:87], v[64:79]
  s_waitcnt lgkmcnt(0)
  v_mfma_f32_32x32x16_bf16 v[16:31], v[192:195], v[88:91], v[16:31]
  s_barrier
  ds_read_b64_tr_b16 v[184:185], v134 offset:32768
  ds_read_b64_tr_b16 v[186:187], v134 offset:33280
  v_mfma_f32_32x32x16_bf16 v[32:47], v[196:199], v[88:91], v[32:47]
  ds_read_b64_tr_b16 v[188:189], v135 offset:32768
  ds_read_b64_tr_b16 v[190:191], v135 offset:33280
  v_mfma_f32_32x32x16_bf16 v[48:63], v[192:195], v[92:95], v[48:63]
  ds_read_b128 v[80:83], v128 offset:32768
  ds_read_b128 v[84:87], v128 offset:36864
  v_mfma_f32_32x32x16_bf16 v[64:79], v[196:199], v[92:95], v[64:79]
  s_waitcnt lgkmcnt(6)
  v_mfma_f32_32x32x16_bf16 v[16:31], v[200:203], v[96:99], v[16:31]
  ds_read_b64_tr_b16 v[192:193], v134 offset:34816
  ds_read_b64_tr_b16 v[194:195], v134 offset:35328
  v_mfma_f32_32x32x16_bf16 v[32:47], v[204:207], v[96:99], v[32:47]
  ds_read_b64_tr_b16 v[196:197], v135 offset:34816
  ds_read_b64_tr_b16 v[198:199], v135 offset:35328
  v_mfma_f32_32x32x16_bf16 v[48:63], v[200:203], v[100:103], v[48:63]
  ds_read_b128 v[88:91], v129 offset:32768
  ds_read_b128 v[92:95], v129 offset:36864
  v_mfma_f32_32x32x16_bf16 v[64:79], v[204:207], v[100:103], v[64:79]
  s_waitcnt lgkmcnt(6)
  v_mfma_f32_32x32x16_bf16 v[16:31], v[184:187], v[80:83], v[16:31]
  ds_read_b64_tr_b16 v[200:201], v134 offset:36864
  ds_read_b64_tr_b16 v[202:203], v134 offset:37376
  v_mfma_f32_32x32x16_bf16 v[32:47], v[188:191], v[80:83], v[32:47]
  ds_read_b64_tr_b16 v[204:205], v135 offset:36864
  ds_read_b64_tr_b16 v[206:207], v135 offset:37376
  v_mfma_f32_32x32x16_bf16 v[48:63], v[184:187], v[84:87], v[48:63]
  ds_read_b128 v[96:99], v130 offset:32768
  ds_read_b128 v[100:103], v130 offset:36864
  v_mfma_f32_32x32x16_bf16 v[64:79], v[188:191], v[84:87], v[64:79]
  s_waitcnt lgkmcnt(6)
  v_mfma_f32_32x32x16_bf16 v[16:31], v[192:195], v[88:91], v[16:31]
  ds_read_b64_tr_b16 v[184:185], v134 offset:38912
  ds_read_b64_tr_b16 v[186:187], v134 offset:39424
  v_mfma_f32_32x32x16_bf16 v[32:47], v[196:199], v[88:91], v[32:47]
  ds_read_b64_tr_b16 v[188:189], v135 offset:38912
  ds_read_b64_tr_b16 v[190:191], v135 offset:39424
  v_mfma_f32_32x32x16_bf16 v[48:63], v[192:195], v[92:95], v[48:63]
  ds_read_b128 v[80:83], v131 offset:32768
  ds_read_b128 v[84:87], v131 offset:36864
  v_mfma_f32_32x32x16_bf16 v[64:79], v[196:199], v[92:95], v[64:79]
  s_waitcnt lgkmcnt(0)
  v_mfma_f32_32x32x16_bf16 v[16:31], v[200:203], v[96:99], v[16:31]
  s_barrier
  ds_read_b64_tr_b16 v[192:193], v132 offset:0
  ds_read_b64_tr_b16 v[194:195], v132 offset:512
  v_mfma_f32_32x32x16_bf16 v[32:47], v[204:207], v[96:99], v[32:47]
  ds_read_b64_tr_b16 v[196:197], v133 offset:0
  ds_read_b64_tr_b16 v[198:199], v133 offset:512
  v_mfma_f32_32x32x16_bf16 v[48:63], v[200:203], v[100:103], v[48:63]
  ds_read_b128 v[88:91], v124 offset:0
  ds_read_b128 v[92:95], v124 offset:4096
  v_mfma_f32_32x32x16_bf16 v[64:79], v[204:207], v[100:103], v[64:79]
  s_waitcnt lgkmcnt(6)
  v_mfma_f32_32x32x16_bf16 v[16:31], v[184:187], v[80:83], v[16:31]
  ds_read_b64_tr_b16 v[200:201], v132 offset:2048
  ds_read_b64_tr_b16 v[202:203], v132 offset:2560
  v_mfma_f32_32x32x16_bf16 v[32:47], v[188:191], v[80:83], v[32:47]
  ds_read_b64_tr_b16 v[204:205], v133 offset:2048
  ds_read_b64_tr_b16 v[206:207], v133 offset:2560
  v_mfma_f32_32x32x16_bf16 v[48:63], v[184:187], v[84:87], v[48:63]
  ds_read_b128 v[96:99], v125 offset:0
  ds_read_b128 v[100:103], v125 offset:4096
  v_mfma_f32_32x32x16_bf16 v[64:79], v[188:191], v[84:87], v[64:79]
  s_waitcnt lgkmcnt(6)
  v_mfma_f32_32x32x16_bf16 v[16:31], v[192:195], v[88:91], v[16:31]
  ds_read_b64_tr_b16 v[184:185], v132 offset:4096
  ds_read_b64_tr_b16 v[186:187], v132 offset:4608
  v_mfma_f32_32x32x16_bf16 v[32:47], v[196:199], v[88:91], v[32:47]
  ds_read_b64_tr_b16 v[188:189], v133 offset:4096
  ds_read_b64_tr_b16 v[190:191], v133 offset:4608
  v_mfma_f32_32x32x16_bf16 v[48:63], v[192:195], v[92:95], v[48:63]
  ds_read_b128 v[80:83], v126 offset:0
  ds_read_b128 v[84:87], v126 offset:4096
  v_mfma_f32_32x32x16_bf16 v[64:79], v[196:199], v[92:95], v[64:79]
  s_waitcnt lgkmcnt(6)
  v_mfma_f32_32x32x16_bf16 v[16:31], v[200:203], v[96:99], v[16:31]
  ds_read_b64_tr_b16 v[192:193], v132 offset:6144
  ds_read_b64_tr_b16 v[194:195], v132 offset:6656
  v_mfma_f32_32x32x16_bf16 v[32:47], v[204:207], v[96:99], v[32:47]
  ds_read_b64_tr_b16 v[196:197], v133 offset:6144
  ds_read_b64_tr_b16 v[198:199], v133 offset:6656
  v_mfma_f32_32x32x16_bf16 v[48:63], v[200:203], v[100:103], v[48:63]
  ds_read_b128 v[88:91], v127 offset:0
  ds_read_b128 v[92:95], v127 offset:4096
  v_mfma_f32_32x32x16_bf16 v[64:79], v[204:207], v[100:103], v[64:79]
  s_waitcnt lgkmcnt(0)
  v_mfma_f32_32x32x16_bf16 v[16:31], v[184:187], v[80:83], v[16:31]
  s_barrier
  ds_read_b64_tr_b16 v[200:201], v132 offset:32768
  ds_read_b64_tr_b16 v[202:203], v132 offset:33280
  v_mfma_f32_32x32x16_bf16 v[32:47], v[188:191], v[80:83], v[32:47]
  ds_read_b64_tr_b16 v[204:205], v133 offset:32768
  ds_read_b64_tr_b16 v[206:207], v133 offset:33280
  v_mfma_f32_32x32x16_bf16 v[48:63], v[184:187], v[84:87], v[48:63]
  ds_read_b128 v[96:99], v124 offset:32768
  ds_read_b128 v[100:103], v124 offset:36864
  v_mfma_f32_32x32x16_bf16 v[64:79], v[188:191], v[84:87], v[64:79]
  s_waitcnt lgkmcnt(6)
  v_mfma_f32_32x32x16_bf16 v[16:31], v[192:195], v[88:91], v[16:31]
  ds_read_b64_tr_b16 v[184:185], v132 offset:34816
  ds_read_b64_tr_b16 v[186:187], v132 offset:35328
  v_mfma_f32_32x32x16_bf16 v[32:47], v[196:199], v[88:91], v[32:47]
  ds_read_b64_tr_b16 v[188:189], v133 offset:34816
  ds_read_b64_tr_b16 v[190:191], v133 offset:35328
  v_mfma_f32_32x32x16_bf16 v[48:63], v[192:195], v[92:95], v[48:63]
  ds_read_b128 v[80:83], v125 offset:32768
  ds_read_b128 v[84:87], v125 offset:36864
  v_mfma_f32_32x32x16_bf16 v[64:79], v[196:199], v[92:95], v[64:79]
  s_waitcnt lgkmcnt(6)
  v_mfma_f32_32x32x16_bf16 v[16:31], v[200:203], v[96:99], v[16:31]
  ds_read_b64_tr_b16 v[192:193], v132 offset:36864
  ds_read_b64_tr_b16 v[194:195], v132 offset:37376
  v_mfma_f32_32x32x16_bf16 v[32:47], v[204:207], v[96:99], v[32:47]
  ds_read_b64_tr_b16 v[196:197], v133 offset:36864
  ds_read_b64_tr_b16 v[198:199], v133 offset:37376
  v_mfma_f32_32x32x16_bf16 v[48:63], v[200:203], v[100:103], v[48:63]
  ds_read_b128 v[88:91], v126 offset:32768
  ds_read_b128 v[92:95], v126 offset:36864
  v_mfma_f32_32x32x16_bf16 v[64:79], v[204:207], v[100:103], v[64:79]
  s_waitcnt lgkmcnt(6)
  v_mfma_f32_32x32x16_bf16 v[16:31], v[184:187], v[80:83], v[16:31]
  ds_read_b64_tr_b16 v[200:201], v132 offset:38912
  ds_read_b64_tr_b16 v[202:203], v132 offset:39424
  v_mfma_f32_32x32x16_bf16 v[32:47], v[188:191], v[80:83], v[32:47]
  ds_read_b64_tr_b16 v[204:205], v133 offset:38912
  ds_read_b64_tr_b16 v[206:207], v133 offset:39424
  v_mfma_f32_32x32x16_bf16 v[48:63], v[184:187], v[84:87], v[48:63]
  ds_read_b128 v[96:99], v127 offset:32768
  ds_read_b128 v[100:103], v127 offset:36864
  v_mfma_f32_32x32x16_bf16 v[64:79], v[188:191], v[84:87], v[64:79]
  s_waitcnt lgkmcnt(0)
  v_mfma_f32_32x32x16_bf16 v[16:31], v[192:195], v[88:91], v[16:31]
  s_barrier
  ds_read_b64_tr_b16 v[184:185], v134 offset:0
  ds_read_b64_tr_b16 v[186:187], v134 offset:512
  v_mfma_f32_32x32x16_bf16 v[32:47], v[196:199], v[88:91], v[32:47]
  ds_read_b64_tr_b16 v[188:189], v135 offset:0
  ds_read_b64_tr_b16 v[190:191], v135 offset:512
  v_mfma_f32_32x32x16_bf16 v[48:63], v[192:195], v[92:95], v[48:63]
  ds_read_b128 v[80:83], v128 offset:0
  ds_read_b128 v[84:87], v128 offset:4096
  v_mfma_f32_32x32x16_bf16 v[64:79], v[196:199], v[92:95], v[64:79]
  s_waitcnt lgkmcnt(6)
  v_mfma_f32_32x32x16_bf16 v[16:31], v[200:203], v[96:99], v[16:31]
  ds_read_b64_tr_b16 v[192:193], v134 offset:2048
  ds_read_b64_tr_b16 v[194:195], v134 offset:2560
  v_mfma_f32_32x32x16_bf16 v[32:47], v[204:207], v[96:99], v[32:47]
  ds_read_b64_tr_b16 v[196:197], v135 offset:2048
  ds_read_b64_tr_b16 v[198:199], v135 offset:2560
  v_mfma_f32_32x32x16_bf16 v[48:63], v[200:203], v[100:103], v[48:63]
  ds_read_b128 v[88:91], v129 offset:0
  ds_read_b128 v[92:95], v129 offset:4096
  v_mfma_f32_32x32x16_bf16 v[64:79], v[204:207], v[100:103], v[64:79]
  s_waitcnt lgkmcnt(6)
  v_mfma_f32_32x32x16_bf16 v[16:31], v[184:187], v[80:83], v[16:31]
  ds_read_b64_tr_b16 v[200:201], v134 offset:4096
  ds_read_b64_tr_b16 v[202:203], v134 offset:4608
  v_mfma_f32_32x32x16_bf16 v[32:47], v[188:191], v[80:83], v[32:47]
  ds_read_b64_tr_b16 v[204:205], v135 offset:4096
  ds_read_b64_tr_b16 v[206:207], v135 offset:4608
  v_mfma_f32_32x32x16_bf16 v[48:63], v[184:187], v[84:87], v[48:63]
  ds_read_b128 v[96:99], v130 offset:0
  ds_read_b128 v[100:103], v130 offset:4096
  v_mfma_f32_32x32x16_bf16 v[64:79], v[188:191], v[84:87], v[64:79]
  s_waitcnt lgkmcnt(6)
  v_mfma_f32_32x32x16_bf16 v[16:31], v[192:195], v[88:91], v[16:31]
  ds_read_b64_tr_b16 v[184:185], v134 offset:6144
  ds_read_b64_tr_b16 v[186:187], v134 offset:6656
  v_mfma_f32_32x32x16_bf16 v[32:47], v[196:199], v[88:91], v[32:47]
  ds_read_b64_tr_b16 v[188:189], v135 offset:6144
  ds_read_b64_tr_b16 v[190:191], v135 offset:6656
  v_mfma_f32_32x32x16_bf16 v[48:63], v[192:195], v[92:95], v[48:63]
  ds_read_b128 v[80:83], v131 offset:0
  ds_read_b128 v[84:87], v131 offset:4096
  v_mfma_f32_32x32x16_bf16 v[64:79], v[196:199], v[92:95], v[64:79]
  s_waitcnt lgkmcnt(0)
  v_mfma_f32_32x32x16_bf16 v[16:31], v[200:203], v[96:99], v[16:31]
  s_barrier
  ds_read_b64_tr_b16 v[192:193], v134 offset:32768
  ds_read_b64_tr_b16 v[194:195], v134 offset:33280
  v_mfma_f32_32x32x16_bf16 v[32:47], v[204:207], v[96:99], v[32:47]
  ds_read_b64_tr_b16 v[196:197], v135 offset:32768
  ds_read_b64_tr_b16 v[198:199], v135 offset:33280
  v_mfma_f32_32x32x16_bf16 v[48:63], v[200:203], v[100:103], v[48:63]
  ds_read_b128 v[88:91], v128 offset:32768
  ds_read_b128 v[92:95], v128 offset:36864
  v_mfma_f32_32x32x16_bf16 v[64:79], v[204:207], v[100:103], v[64:79]
  s_waitcnt lgkmcnt(6)
  v_mfma_f32_32x32x16_bf16 v[16:31], v[184:187], v[80:83], v[16:31]
  ds_read_b64_tr_b16 v[200:201], v134 offset:34816
  ds_read_b64_tr_b16 v[202:203], v134 offset:35328
  v_mfma_f32_32x32x16_bf16 v[32:47], v[188:191], v[80:83], v[32:47]
  ds_read_b64_tr_b16 v[204:205], v135 offset:34816
  ds_read_b64_tr_b16 v[206:207], v135 offset:35328
  v_mfma_f32_32x32x16_bf16 v[48:63], v[184:187], v[84:87], v[48:63]
  ds_read_b128 v[96:99], v129 offset:32768
  ds_read_b128 v[100:103], v129 offset:36864
  v_mfma_f32_32x32x16_bf16 v[64:79], v[188:191], v[84:87], v[64:79]
  s_waitcnt lgkmcnt(6)
  v_mfma_f32_32x32x16_bf16 v[16:31], v[192:195], v[88:91], v[16:31]
  ds_read_b64_tr_b16 v[184:185], v134 offset:36864
  ds_read_b64_tr_b16 v[186:187], v134 offset:37376
  v_mfma_f32_32x32x16_bf16 v[32:47], v[196:199], v[88:91], v[32:47]
  ds_read_b64_tr_b16 v[188:189], v135 offset:36864
  ds_read_b64_tr_b16 v[190:191], v135 offset:37376
  v_mfma_f32_32x32x16_bf16 v[48:63], v[192:195], v[92:95], v[48:63]
  ds_read_b128 v[80:83], v130 offset:32768
  ds_read_b128 v[84:87], v130 offset:36864
  v_mfma_f32_32x32x16_bf16 v[64:79], v[196:199], v[92:95], v[64:79]
  s_waitcnt lgkmcnt(6)
  v_mfma_f32_32x32x16_bf16 v[16:31], v[200:203], v[96:99], v[16:31]
  ds_read_b64_tr_b16 v[192:193], v134 offset:38912
  ds_read_b64_tr_b16 v[194:195], v134 offset:39424
  v_mfma_f32_32x32x16_bf16 v[32:47], v[204:207], v[96:99], v[32:47]
  ds_read_b64_tr_b16 v[196:197], v135 offset:38912
  ds_read_b64_tr_b16 v[198:199], v135 offset:39424
  v_mfma_f32_32x32x16_bf16 v[48:63], v[200:203], v[100:103], v[48:63]
  ds_read_b128 v[88:91], v131 offset:32768
  ds_read_b128 v[92:95], v131 offset:36864
  v_mfma_f32_32x32x16_bf16 v[64:79], v[204:207], v[100:103], v[64:79]
  s_waitcnt lgkmcnt(0)
  v_mfma_f32_32x32x16_bf16 v[16:31], v[184:187], v[80:83], v[16:31]
  v_mfma_f32_32x32x16_bf16 v[32:47], v[188:191], v[80:83], v[32:47]
  v_mfma_f32_32x32x16_bf16 v[48:63], v[184:187], v[84:87], v[48:63]
  v_mfma_f32_32x32x16_bf16 v[64:79], v[188:191], v[84:87], v[64:79]
  s_waitcnt lgkmcnt(0)
  v_mfma_f32_32x32x16_bf16 v[16:31], v[192:195], v[88:91], v[16:31]
  v_mfma_f32_32x32x16_bf16 v[32:47], v[196:199], v[88:91], v[32:47]
  v_mfma_f32_32x32x16_bf16 v[48:63], v[192:195], v[92:95], v[48:63]
  v_mfma_f32_32x32x16_bf16 v[64:79], v[196:199], v[92:95], v[64:79]
L_Aepi0:
  s_barrier
  s_and_b32 s40, s33, 1
  s_lshr_b32 s41, s33, 1
  v_and_b32 v2, 31, v1
  v_lshlrev_b32 v2, 2, v2
  s_lshl_b32 s42, s40, 8
  s_add_u32 s42, s42, 155648
  v_add_u32 v2, s42, v2
  ds_read_b32 v80, v2 offset:0
  ds_read_b32 v82, v2 offset:512
  ds_read_b32 v81, v2 offset:128
  ds_read_b32 v83, v2 offset:640
  v_lshrrev_b32 v3, 5, v1
  v_lshlrev_b32 v3, 4, v3
  s_lshl_b32 s42, s41, 8
  s_add_u32 s42, s42, 156672
  v_add_u32 v3, s42, v3
  s_lshl_b32 s42, s40, 7
  v_xor_b32 v140, s42, v3
  v_xor_b32 v141, 128, v140
  ds_read_b128 v[84:87], v140 offset:0
  ds_read_b128 v[88:91], v140 offset:32
  ds_read_b128 v[92:95], v140 offset:64
  ds_read_b128 v[96:99], v140 offset:96
  ds_read_b128 v[100:103], v141 offset:0
  ds_read_b128 v[104:107], v141 offset:32
  ds_read_b128 v[108:111], v141 offset:64
  ds_read_b128 v[112:115], v141 offset:96
  v_lshlrev_b32 v142, 4, v1
  s_lshl_b32 s42, s34, 2
  s_lshl_b32 s43, s40, 1
  s_add_u32 s42, s42, s43
  s_mul_i32 s42, s42, 112
  s_lshr_b32 s43, s58, 4
  s_lshl_b32 s44, s41, 2
  s_add_u32 s43, s43, s44
  s_add_u32 s42, s42, s43
  s_lshl_b32 s55, s42, 10
  s_add_u32 s55, s55, 1048576
  s_lshl_b32 s45, s40, 11
  s_add_u32 s60, s55, s45
  s_xor_b32 s45, s45, 2048
  s_add_u32 s61, s55, s45
  s_waitcnt lgkmcnt(0)
  v_mul_f32 v116, v82, v84
  v_mul_f32 v117, v82, v85
  v_mul_f32 v118, v82, v86
  v_mul_f32 v119, v82, v87
  v_mul_f32 v120, v82, v88
  v_mul_f32 v121, v82, v89
  v_mul_f32 v122, v82, v90
  v_mul_f32 v123, v82, v91
  v_fma_f32 v116, v16, v80, v116
  v_fma_f32 v117, v17, v80, v117
  v_fma_f32 v118, v18, v80, v118
  v_fma_f32 v119, v19, v80, v119
  v_fma_f32 v120, v20, v80, v120
  v_fma_f32 v121, v21, v80, v121
  v_fma_f32 v122, v22, v80, v122
  v_fma_f32 v123, v23, v80, v123
  v_exp_f32 v124, -v116
  v_exp_f32 v125, -v117
  v_exp_f32 v126, -v118
  v_exp_f32 v127, -v119
  v_exp_f32 v128, -v120
  v_exp_f32 v129, -v121
  v_exp_f32 v130, -v122
  v_exp_f32 v131, -v123
  v_add_f32 v124, 1.0, v124
  v_add_f32 v125, 1.0, v125
  v_add_f32 v126, 1.0, v126
  v_add_f32 v127, 1.0, v127
  v_add_f32 v128, 1.0, v128
  v_add_f32 v129, 1.0, v129
  v_add_f32 v130, 1.0, v130
  v_add_f32 v131, 1.0, v131
  v_rcp_f32 v124, v124
  v_rcp_f32 v125, v125
  v_rcp_f32 v126, v126
  v_rcp_f32 v127, v127
  v_rcp_f32 v128, v128
  v_rcp_f32 v129, v129
  v_rcp_f32 v130, v130
  v_rcp_f32 v131, v131
  v_mul_f32 v116, v116, v124
  v_mul_f32 v117, v117, v125
  v_mul_f32 v118, v118, v126
  v_mul_f32 v119, v119, v127
  v_mul_f32 v120, v120, v128
  v_mul_f32 v121, v121, v129
  v_mul_f32 v122, v122, v130
  v_mul_f32 v123, v123, v131
  v_cvt_pk_bf16_f32 v132, v116, v117
  v_cvt_pk_bf16_f32 v133, v118, v119
  v_cvt_pk_bf16_f32 v134, v120, v121
  v_cvt_pk_bf16_f32 v135, v122, v123
  s_add_u32 s42, s60, 0
  buffer_store_dwordx4 v[132:135], v142, s[12:15], s42 offen sc1
  v_mul_f32 v116, v83, v84
  v_mul_f32 v117, v83, v85
  v_mul_f32 v118, v83, v86
  v_mul_f32 v119, v83, v87
  v_mul_f32 v120, v83, v88
  v_mul_f32 v121, v83, v89
  v_mul_f32 v122, v83, v90
  v_mul_f32 v123, v83, v91
  v_fma_f32 v116, v48, v81, v116
  v_fma_f32 v117, v49, v81, v117
  v_fma_f32 v118, v50, v81, v118
  v_fma_f32 v119, v51, v81, v119
  v_fma_f32 v120, v52, v81, v120
  v_fma_f32 v121, v53, v81, v121
  v_fma_f32 v122, v54, v81, v122
  v_fma_f32 v123, v55, v81, v123
  v_exp_f32 v124, -v116
  v_exp_f32 v125, -v117
  v_exp_f32 v126, -v118
  v_exp_f32 v127, -v119
  v_exp_f32 v128, -v120
  v_exp_f32 v129, -v121
  v_exp_f32 v130, -v122
  v_exp_f32 v131, -v123
  v_add_f32 v124, 1.0, v124
  v_add_f32 v125, 1.0, v125
  v_add_f32 v126, 1.0, v126
  v_add_f32 v127, 1.0, v127
  v_add_f32 v128, 1.0, v128
  v_add_f32 v129, 1.0, v129
  v_add_f32 v130, 1.0, v130
  v_add_f32 v131, 1.0, v131
  v_rcp_f32 v124, v124
  v_rcp_f32 v125, v125
  v_rcp_f32 v126, v126
  v_rcp_f32 v127, v127
  v_rcp_f32 v128, v128
  v_rcp_f32 v129, v129
  v_rcp_f32 v130, v130
  v_rcp_f32 v131, v131
  v_mul_f32 v116, v116, v124
  v_mul_f32 v117, v117, v125
  v_mul_f32 v118, v118, v126
  v_mul_f32 v119, v119, v127
  v_mul_f32 v120, v120, v128
  v_mul_f32 v121, v121, v129
  v_mul_f32 v122, v122, v130
  v_mul_f32 v123, v123, v131
  v_cvt_pk_bf16_f32 v136, v116, v117
  v_cvt_pk_bf16_f32 v137, v118, v119
  v_cvt_pk_bf16_f32 v138, v120, v121
  v_cvt_pk_bf16_f32 v139, v122, v123
  s_add_u32 s42, s60, 114688
  buffer_store_dwordx4 v[136:139], v142, s[12:15], s42 offen sc1
  s_lshl_b32 s42, s63, 7
  s_lshr_b32 s41, s2, 3
  s_and_b32 s41, s41, 7
  s_mul_i32 s43, s41, 224
  s_mul_i32 s44, s33, 56
  s_add_u32 s43, s43, s44
  s_lshl_b32 s43, s43, 10
  s_add_u32 s43, s43, s42
  v_min_u32 v2, 55, v1
  v_lshlrev_b32 v2, 10, v2
  buffer_load_dword v255, v2, s[16:19], s43 offen
  s_lshl_b32 s43, s41, 6
  s_lshl_b32 s44, s33, 4
  s_add_u32 s43, s43, s44
  s_lshl_b32 s43, s43, 10
  s_add_u32 s43, s43, s42
  v_and_b32 v2, 15, v1
  v_lshlrev_b32 v2, 10, v2
  s_mov_b64 exec, 0xffff
  buffer_load_dword v255, v2, s[20:23], s43 offen
  s_mov_b64 exec, -1
  v_mul_f32 v116, v82, v92
  v_mul_f32 v117, v82, v93
  v_mul_f32 v118, v82, v94
  v_mul_f32 v119, v82, v95
  v_mul_f32 v120, v82, v96
  v_mul_f32 v121, v82, v97
  v_mul_f32 v122, v82, v98
  v_mul_f32 v123, v82, v99
  v_fma_f32 v116, v24, v80, v116
  v_fma_f32 v117, v25, v80, v117
  v_fma_f32 v118, v26, v80, v118
  v_fma_f32 v119, v27, v80, v119
  v_fma_f32 v120, v28, v80, v120
  v_fma_f32 v121, v29, v80, v121
  v_fma_f32 v122, v30, v80, v122
  v_fma_f32 v123, v31, v80, v123
  v_exp_f32 v124, -v116
  v_exp_f32 v125, -v117
  v_exp_f32 v126, -v118
  v_exp_f32 v127, -v119
  v_exp_f32 v128, -v120
  v_exp_f32 v129, -v121
  v_exp_f32 v130, -v122
  v_exp_f32 v131, -v123
  v_add_f32 v124, 1.0, v124
  v_add_f32 v125, 1.0, v125
  v_add_f32 v126, 1.0, v126
  v_add_f32 v127, 1.0, v127
  v_add_f32 v128, 1.0, v128
  v_add_f32 v129, 1.0, v129
  v_add_f32 v130, 1.0, v130
  v_add_f32 v131, 1.0, v131
  v_rcp_f32 v124, v124
  v_rcp_f32 v125, v125
  v_rcp_f32 v126, v126
  v_rcp_f32 v127, v127
  v_rcp_f32 v128, v128
  v_rcp_f32 v129, v129
  v_rcp_f32 v130, v130
  v_rcp_f32 v131, v131
  v_mul_f32 v116, v116, v124
  v_mul_f32 v117, v117, v125
  v_mul_f32 v118, v118, v126
  v_mul_f32 v119, v119, v127
  v_mul_f32 v120, v120, v128
  v_mul_f32 v121, v121, v129
  v_mul_f32 v122, v122, v130
  v_mul_f32 v123, v123, v131
  v_cvt_pk_bf16_f32 v132, v116, v117
  v_cvt_pk_bf16_f32 v133, v118, v119
  v_cvt_pk_bf16_f32 v134, v120, v121
  v_cvt_pk_bf16_f32 v135, v122, v123
  s_add_u32 s42, s60, 1024
  buffer_store_dwordx4 v[132:135], v142, s[12:15], s42 offen sc1
  v_mul_f32 v116, v83, v92
  v_mul_f32 v117, v83, v93
  v_mul_f32 v118, v83, v94
  v_mul_f32 v119, v83, v95
  v_mul_f32 v120, v83, v96
  v_mul_f32 v121, v83, v97
  v_mul_f32 v122, v83, v98
  v_mul_f32 v123, v83, v99
  v_fma_f32 v116, v56, v81, v116
  v_fma_f32 v117, v57, v81, v117
  v_fma_f32 v118, v58, v81, v118
  v_fma_f32 v119, v59, v81, v119
  v_fma_f32 v120, v60, v81, v120
  v_fma_f32 v121, v61, v81, v121
  v_fma_f32 v122, v62, v81, v122
  v_fma_f32 v123, v63, v81, v123
  v_exp_f32 v124, -v116
  v_exp_f32 v125, -v117
  v_exp_f32 v126, -v118
  v_exp_f32 v127, -v119
  v_exp_f32 v128, -v120
  v_exp_f32 v129, -v121
  v_exp_f32 v130, -v122
  v_exp_f32 v131, -v123
  v_add_f32 v124, 1.0, v124
  v_add_f32 v125, 1.0, v125
  v_add_f32 v126, 1.0, v126
  v_add_f32 v127, 1.0, v127
  v_add_f32 v128, 1.0, v128
  v_add_f32 v129, 1.0, v129
  v_add_f32 v130, 1.0, v130
  v_add_f32 v131, 1.0, v131
  v_rcp_f32 v124, v124
  v_rcp_f32 v125, v125
  v_rcp_f32 v126, v126
  v_rcp_f32 v127, v127
  v_rcp_f32 v128, v128
  v_rcp_f32 v129, v129
  v_rcp_f32 v130, v130
  v_rcp_f32 v131, v131
  v_mul_f32 v116, v116, v124
  v_mul_f32 v117, v117, v125
  v_mul_f32 v118, v118, v126
  v_mul_f32 v119, v119, v127
  v_mul_f32 v120, v120, v128
  v_mul_f32 v121, v121, v129
  v_mul_f32 v122, v122, v130
  v_mul_f32 v123, v123, v131
  v_cvt_pk_bf16_f32 v136, v116, v117
  v_cvt_pk_bf16_f32 v137, v118, v119
  v_cvt_pk_bf16_f32 v138, v120, v121
  v_cvt_pk_bf16_f32 v139, v122, v123
  s_add_u32 s42, s60, 115712
  buffer_store_dwordx4 v[136:139], v142, s[12:15], s42 offen sc1
  v_mul_f32 v116, v82, v100
  v_mul_f32 v117, v82, v101
  v_mul_f32 v118, v82, v102
  v_mul_f32 v119, v82, v103
  v_mul_f32 v120, v82, v104
  v_mul_f32 v121, v82, v105
  v_mul_f32 v122, v82, v106
  v_mul_f32 v123, v82, v107
  v_fma_f32 v116, v32, v80, v116
  v_fma_f32 v117, v33, v80, v117
  v_fma_f32 v118, v34, v80, v118
  v_fma_f32 v119, v35, v80, v119
  v_fma_f32 v120, v36, v80, v120
  v_fma_f32 v121, v37, v80, v121
  v_fma_f32 v122, v38, v80, v122
  v_fma_f32 v123, v39, v80, v123
  v_exp_f32 v124, -v116
  v_exp_f32 v125, -v117
  v_exp_f32 v126, -v118
  v_exp_f32 v127, -v119
  v_exp_f32 v128, -v120
  v_exp_f32 v129, -v121
  v_exp_f32 v130, -v122
  v_exp_f32 v131, -v123
  v_add_f32 v124, 1.0, v124
  v_add_f32 v125, 1.0, v125
  v_add_f32 v126, 1.0, v126
  v_add_f32 v127, 1.0, v127
  v_add_f32 v128, 1.0, v128
  v_add_f32 v129, 1.0, v129
  v_add_f32 v130, 1.0, v130
  v_add_f32 v131, 1.0, v131
  v_rcp_f32 v124, v124
  v_rcp_f32 v125, v125
  v_rcp_f32 v126, v126
  v_rcp_f32 v127, v127
  v_rcp_f32 v128, v128
  v_rcp_f32 v129, v129
  v_rcp_f32 v130, v130
  v_rcp_f32 v131, v131
  v_mul_f32 v116, v116, v124
  v_mul_f32 v117, v117, v125
  v_mul_f32 v118, v118, v126
  v_mul_f32 v119, v119, v127
  v_mul_f32 v120, v120, v128
  v_mul_f32 v121, v121, v129
  v_mul_f32 v122, v122, v130
  v_mul_f32 v123, v123, v131
  v_cvt_pk_bf16_f32 v132, v116, v117
  v_cvt_pk_bf16_f32 v133, v118, v119
  v_cvt_pk_bf16_f32 v134, v120, v121
  v_cvt_pk_bf16_f32 v135, v122, v123
  s_add_u32 s42, s61, 0
  buffer_store_dwordx4 v[132:135], v142, s[12:15], s42 offen sc1
  v_mul_f32 v116, v83, v100
  v_mul_f32 v117, v83, v101
  v_mul_f32 v118, v83, v102
  v_mul_f32 v119, v83, v103
  v_mul_f32 v120, v83, v104
  v_mul_f32 v121, v83, v105
  v_mul_f32 v122, v83, v106
  v_mul_f32 v123, v83, v107
  v_fma_f32 v116, v64, v81, v116
  v_fma_f32 v117, v65, v81, v117
  v_fma_f32 v118, v66, v81, v118
  v_fma_f32 v119, v67, v81, v119
  v_fma_f32 v120, v68, v81, v120
  v_fma_f32 v121, v69, v81, v121
  v_fma_f32 v122, v70, v81, v122
  v_fma_f32 v123, v71, v81, v123
  v_exp_f32 v124, -v116
  v_exp_f32 v125, -v117
  v_exp_f32 v126, -v118
  v_exp_f32 v127, -v119
  v_exp_f32 v128, -v120
  v_exp_f32 v129, -v121
  v_exp_f32 v130, -v122
  v_exp_f32 v131, -v123
  v_add_f32 v124, 1.0, v124
  v_add_f32 v125, 1.0, v125
  v_add_f32 v126, 1.0, v126
  v_add_f32 v127, 1.0, v127
  v_add_f32 v128, 1.0, v128
  v_add_f32 v129, 1.0, v129
  v_add_f32 v130, 1.0, v130
  v_add_f32 v131, 1.0, v131
  v_rcp_f32 v124, v124
  v_rcp_f32 v125, v125
  v_rcp_f32 v126, v126
  v_rcp_f32 v127, v127
  v_rcp_f32 v128, v128
  v_rcp_f32 v129, v129
  v_rcp_f32 v130, v130
  v_rcp_f32 v131, v131
  v_mul_f32 v116, v116, v124
  v_mul_f32 v117, v117, v125
  v_mul_f32 v118, v118, v126
  v_mul_f32 v119, v119, v127
  v_mul_f32 v120, v120, v128
  v_mul_f32 v121, v121, v129
  v_mul_f32 v122, v122, v130
  v_mul_f32 v123, v123, v131
  v_cvt_pk_bf16_f32 v136, v116, v117
  v_cvt_pk_bf16_f32 v137, v118, v119
  v_cvt_pk_bf16_f32 v138, v120, v121
  v_cvt_pk_bf16_f32 v139, v122, v123
  s_add_u32 s42, s61, 114688
  buffer_store_dwordx4 v[136:139], v142, s[12:15], s42 offen sc1
  v_mul_f32 v116, v82, v108
  v_mul_f32 v117, v82, v109
  v_mul_f32 v118, v82, v110
  v_mul_f32 v119, v82, v111
  v_mul_f32 v120, v82, v112
  v_mul_f32 v121, v82, v113
  v_mul_f32 v122, v82, v114
  v_mul_f32 v123, v82, v115
  v_fma_f32 v116, v40, v80, v116
  v_fma_f32 v117, v41, v80, v117
  v_fma_f32 v118, v42, v80, v118
  v_fma_f32 v119, v43, v80, v119
  v_fma_f32 v120, v44, v80, v120
  v_fma_f32 v121, v45, v80, v121
  v_fma_f32 v122, v46, v80, v122
  v_fma_f32 v123, v47, v80, v123
  v_exp_f32 v124, -v116
  v_exp_f32 v125, -v117
  v_exp_f32 v126, -v118
  v_exp_f32 v127, -v119
  v_exp_f32 v128, -v120
  v_exp_f32 v129, -v121
  v_exp_f32 v130, -v122
  v_exp_f32 v131, -v123
  v_add_f32 v124, 1.0, v124
  v_add_f32 v125, 1.0, v125
  v_add_f32 v126, 1.0, v126
  v_add_f32 v127, 1.0, v127
  v_add_f32 v128, 1.0, v128
  v_add_f32 v129, 1.0, v129
  v_add_f32 v130, 1.0, v130
  v_add_f32 v131, 1.0, v131
  v_rcp_f32 v124, v124
  v_rcp_f32 v125, v125
  v_rcp_f32 v126, v126
  v_rcp_f32 v127, v127
  v_rcp_f32 v128, v128
  v_rcp_f32 v129, v129
  v_rcp_f32 v130, v130
  v_rcp_f32 v131, v131
  v_mul_f32 v116, v116, v124
  v_mul_f32 v117, v117, v125
  v_mul_f32 v118, v118, v126
  v_mul_f32 v119, v119, v127
  v_mul_f32 v120, v120, v128
  v_mul_f32 v121, v121, v129
  v_mul_f32 v122, v122, v130
  v_mul_f32 v123, v123, v131
  v_cvt_pk_bf16_f32 v132, v116, v117
  v_cvt_pk_bf16_f32 v133, v118, v119
  v_cvt_pk_bf16_f32 v134, v120, v121
  v_cvt_pk_bf16_f32 v135, v122, v123
  s_waitcnt vmcnt(2)
  s_lshl_b32 s42, s34, 1
  s_and_b32 s43, s33, 1
  s_add_u32 s42, s42, s43
  s_lshl_b32 s42, s42, 7
  s_lshl_b32 s43, s35, 1
  s_lshr_b32 s44, s33, 1
  s_add_u32 s43, s43, s44
  s_lshl_b32 s43, s43, 2
  s_add_u32 s40, s42, s43
  s_add_u32 s40, s40, 0
  v_mov_b32 v2, 0
  v_mov_b32 v3, s1
  s_mov_b64 exec, 1
  buffer_store_dword v3, v2, s[12:15], s40 offen sc1
  s_mov_b64 exec, -1
  s_add_u32 s42, s61, 1024
  buffer_store_dwordx4 v[132:135], v142, s[12:15], s42 offen sc1
  v_mul_f32 v116, v83, v108
  v_mul_f32 v117, v83, v109
  v_mul_f32 v118, v83, v110
  v_mul_f32 v119, v83, v111
  v_mul_f32 v120, v83, v112
  v_mul_f32 v121, v83, v113
  v_mul_f32 v122, v83, v114
  v_mul_f32 v123, v83, v115
  v_fma_f32 v116, v72, v81, v116
  v_fma_f32 v117, v73, v81, v117
  v_fma_f32 v118, v74, v81, v118
  v_fma_f32 v119, v75, v81, v119
  v_fma_f32 v120, v76, v81, v120
  v_fma_f32 v121, v77, v81, v121
  v_fma_f32 v122, v78, v81, v122
  v_fma_f32 v123, v79, v81, v123
  v_exp_f32 v124, -v116
  v_exp_f32 v125, -v117
  v_exp_f32 v126, -v118
  v_exp_f32 v127, -v119
  v_exp_f32 v128, -v120
  v_exp_f32 v129, -v121
  v_exp_f32 v130, -v122
  v_exp_f32 v131, -v123
  v_add_f32 v124, 1.0, v124
  v_add_f32 v125, 1.0, v125
  v_add_f32 v126, 1.0, v126
  v_add_f32 v127, 1.0, v127
  v_add_f32 v128, 1.0, v128
  v_add_f32 v129, 1.0, v129
  v_add_f32 v130, 1.0, v130
  v_add_f32 v131, 1.0, v131
  v_rcp_f32 v124, v124
  v_rcp_f32 v125, v125
  v_rcp_f32 v126, v126
  v_rcp_f32 v127, v127
  v_rcp_f32 v128, v128
  v_rcp_f32 v129, v129
  v_rcp_f32 v130, v130
  v_rcp_f32 v131, v131
  v_mul_f32 v116, v116, v124
  v_mul_f32 v117, v117, v125
  v_mul_f32 v118, v118, v126
  v_mul_f32 v119, v119, v127
  v_mul_f32 v120, v120, v128
  v_mul_f32 v121, v121, v129
  v_mul_f32 v122, v122, v130
  v_mul_f32 v123, v123, v131
  v_cvt_pk_bf16_f32 v136, v116, v117
  v_cvt_pk_bf16_f32 v137, v118, v119
  v_cvt_pk_bf16_f32 v138, v120, v121
  v_cvt_pk_bf16_f32 v139, v122, v123
  s_add_u32 s42, s61, 115712
  buffer_store_dwordx4 v[136:139], v142, s[12:15], s42 offen sc1
  s_lshl_b32 s42, s34, 1
  s_and_b32 s43, s33, 1
  s_add_u32 s42, s42, s43
  s_lshl_b32 s42, s42, 7
  s_lshl_b32 s43, s35, 1
  s_lshr_b32 s44, s33, 1
  s_add_u32 s43, s43, s44
  s_lshl_b32 s43, s43, 2
  s_add_u32 s40, s42, s43
  s_add_u32 s40, s40, 20480
  s_mov_b32 s55, s40
  s_branch L_P2
L_AQ:
  s_and_b32 s40, s33, 1
  s_lshr_b32 s41, s33, 1
  v_and_b32 v2, 31, v1
  v_lshrrev_b32 v3, 5, v1
  v_lshrrev_b32 v4, 1, v2
  v_and_b32 v4, 7, v4
  v_xor_b32 v4, v4, v3
  v_lshlrev_b32 v4, 4, v4
  v_lshlrev_b32 v5, 7, v2
  v_add_u32 v4, v4, v5
  s_lshl_b32 s42, s40, 13
  v_add_u32 v4, s42, v4
  v_xor_b32 v124, 0, v4
  v_add_u32 v128, 65536, v124
  v_xor_b32 v125, 32, v4
  v_add_u32 v129, 65536, v125
  v_xor_b32 v126, 64, v4
  v_add_u32 v130, 65536, v126
  v_xor_b32 v127, 96, v4
  v_add_u32 v131, 65536, v127
  v_lshrrev_b32 v2, 5, v1
  v_lshlrev_b32 v2, 3, v2
  v_and_b32 v3, 15, v1
  v_lshrrev_b32 v4, 2, v3
  v_add_u32 v2, v2, v4
  v_lshlrev_b32 v2, 7, v2
  v_lshrrev_b32 v4, 3, v3
  v_lshlrev_b32 v4, 6, v4
  v_add_u32 v2, v2, v4
  v_lshrrev_b32 v4, 4, v1
  v_and_b32 v4, 1, v4
  v_lshlrev_b32 v4, 5, v4
  v_add_u32 v2, v2, v4
  v_and_b32 v4, 3, v3
  v_lshlrev_b32 v4, 3, v4
  v_add_u32 v2, v2, v4
  s_lshl_b32 s42, s41, 6
  v_xor_b32 v2, s42, v2
  v_add_u32 v132, 16384, v2
  v_add_u32 v133, 24576, v2
  v_add_u32 v134, 65536, v132
  v_add_u32 v135, 65536, v133
  v_and_b32 v2, 15, v1
  v_lshrrev_b32 v3, 4, v1
  v_and_b32 v3, 1, v3
  v_cmp_eq_u32 vcc, v2, v3
  v_mov_b32 v2, 0x3f803f80
  s_nop 0
  v_cndmask_b32 v120, 0, v2, vcc
  v_mov_b32 v121, v120
  v_mov_b32 v122, v120
  v_mov_b32 v123, v120
  s_cmp_ge_u32 s34, 8
  s_cselect_b32 s42, -1, 0
  v_and_b32 v236, s42, v120
  v_and_b32 v237, s42, v121
  v_and_b32 v238, s42, v122
  v_and_b32 v239, s42, v123
  s_not_b32 s42, s42
  v_and_b32 v120, s42, v120
  v_and_b32 v121, s42, v121
  v_and_b32 v122, s42, v122
  v_and_b32 v123, s42, v123
  v_mov_b32 v2, 157688
  v_mov_b32 v3, 0
  ds_write_b32 v2, v3
  ds_write_b32 v2, v3 offset:4
  v_mov_b32 v2, 157648
  v_mov_b32 v4, 0
  v_mov_b32 v5, 0
  v_mov_b32 v6, 0
  v_mov_b32 v7, 0
  ds_write_b128 v2, v[4:7]
  ds_write_b128 v2, v[4:7] offset:16
  s_waitcnt vmcnt(0)
  v_lshlrev_b32 v48, 16, v40
  v_and_b32 v49, 0xffff0000, v40
  v_add_f32 v50, v48, v49
  v_mul_f32 v51, v48, v48
  v_fmac_f32 v51, v49, v49
  v_lshlrev_b32 v48, 16, v41
  v_and_b32 v49, 0xffff0000, v41
  v_add_f32 v50, v50, v48
  v_fmac_f32 v51, v48, v48
  v_add_f32 v50, v50, v49
  v_fmac_f32 v51, v49, v49
  v_lshlrev_b32 v48, 16, v42
  v_and_b32 v49, 0xffff0000, v42
  v_add_f32 v50, v50, v48
  v_fmac_f32 v51, v48, v48
  v_add_f32 v50, v50, v49
  v_fmac_f32 v51, v49, v49
  v_lshlrev_b32 v48, 16, v43
  v_and_b32 v49, 0xffff0000, v43
  v_add_f32 v50, v50, v48
  v_fmac_f32 v51, v48, v48
  v_add_f32 v50, v50, v49
  v_fmac_f32 v51, v49, v49
  v_lshlrev_b32 v48, 16, v44
  v_and_b32 v49, 0xffff0000, v44
  v_add_f32 v52, v48, v49
  v_mul_f32 v53, v48, v48
  v_fmac_f32 v53, v49, v49
  v_lshlrev_b32 v48, 16, v45
  v_and_b32 v49, 0xffff0000, v45
  v_add_f32 v52, v52, v48
  v_fmac_f32 v53, v48, v48
  v_add_f32 v52, v52, v49
  v_fmac_f32 v53, v49, v49
  v_lshlrev_b32 v48, 16, v46
  v_and_b32 v49, 0xffff0000, v46
  v_add_f32 v52, v52, v48
  v_fmac_f32 v53, v48, v48
  v_add_f32 v52, v52, v49
  v_fmac_f32 v53, v49, v49
  v_lshlrev_b32 v48, 16, v47
  v_and_b32 v49, 0xffff0000, v47
  v_add_f32 v52, v52, v48
  v_fmac_f32 v53, v48, v48
  v_add_f32 v52, v52, v49
  v_fmac_f32 v53, v49, v49
  v_add_f32_dpp v50, v50, v50 row_shr:1 row_mask:0xf bank_mask:0xf bound_ctrl:0
  v_add_f32_dpp v51, v51, v51 row_shr:1 row_mask:0xf bank_mask:0xf bound_ctrl:0
  v_add_f32_dpp v52, v52, v52 row_shr:1 row_mask:0xf bank_mask:0xf bound_ctrl:0
  v_add_f32_dpp v53, v53, v53 row_shr:1 row_mask:0xf bank_mask:0xf bound_ctrl:0
  v_add_f32_dpp v50, v50, v50 row_shr:2 row_mask:0xf bank_mask:0xf bound_ctrl:0
  v_add_f32_dpp v51, v51, v51 row_shr:2 row_mask:0xf bank_mask:0xf bound_ctrl:0
  v_add_f32_dpp v52, v52, v52 row_shr:2 row_mask:0xf bank_mask:0xf bound_ctrl:0
  v_add_f32_dpp v53, v53, v53 row_shr:2 row_mask:0xf bank_mask:0xf bound_ctrl:0
  v_add_f32_dpp v50, v50, v50 row_shr:4 row_mask:0xf bank_mask:0xf bound_ctrl:0
  v_add_f32_dpp v51, v51, v51 row_shr:4 row_mask:0xf bank_mask:0xf bound_ctrl:0
  v_add_f32_dpp v52, v52, v52 row_shr:4 row_mask:0xf bank_mask:0xf bound_ctrl:0
  v_add_f32_dpp v53, v53, v53 row_shr:4 row_mask:0xf bank_mask:0xf bound_ctrl:0
  v_add_f32_dpp v50, v50, v50 row_shr:8 row_mask:0xf bank_mask:0xf bound_ctrl:0
  v_add_f32_dpp v51, v51, v51 row_shr:8 row_mask:0xf bank_mask:0xf bound_ctrl:0
  v_add_f32_dpp v52, v52, v52 row_shr:8 row_mask:0xf bank_mask:0xf bound_ctrl:0
  v_add_f32_dpp v53, v53, v53 row_shr:8 row_mask:0xf bank_mask:0xf bound_ctrl:0
  v_add_f32_dpp v50, v50, v50 row_bcast:15 row_mask:0xa bank_mask:0xf
  v_add_f32_dpp v51, v51, v51 row_bcast:15 row_mask:0xa bank_mask:0xf
  v_add_f32_dpp v52, v52, v52 row_bcast:15 row_mask:0xa bank_mask:0xf
  v_add_f32_dpp v53, v53, v53 row_bcast:15 row_mask:0xa bank_mask:0xf
  v_add_f32_dpp v50, v50, v50 row_bcast:31 row_mask:0xc bank_mask:0xf
  v_add_f32_dpp v51, v51, v51 row_bcast:31 row_mask:0xc bank_mask:0xf
  v_add_f32_dpp v52, v52, v52 row_bcast:31 row_mask:0xc bank_mask:0xf
  v_add_f32_dpp v53, v53, v53 row_bcast:31 row_mask:0xc bank_mask:0xf
  v_mul_f32 v50, 0x3b000000, v50
  v_mul_f32 v51, 0x3b000000, v51
  v_fma_f32 v51, -v50, v50, v51
  v_max_f32 v51, 0, v51
  v_add_f32 v51, 0x3727c5ac, v51
  v_rsq_f32 v51, v51
  s_nop 0
  v_mul_f32 v54, 0x3fb8aa3b, v51
  v_mul_f32 v55, v54, v50
  v_sub_f32 v55, 0, v55
  v_mul_f32 v52, 0x3b000000, v52
  v_mul_f32 v53, 0x3b000000, v53
  v_fma_f32 v53, -v52, v52, v53
  v_max_f32 v53, 0, v53
  v_add_f32 v53, 0x3727c5ac, v53
  v_rsq_f32 v53, v53
  s_nop 0
  v_mul_f32 v56, 0x3fb8aa3b, v53
  v_mul_f32 v57, v56, v52
  v_sub_f32 v57, 0, v57
  v_mov_b32 v2, 128
  s_mov_b32 s3, 0
L_gn_17:
  s_add_u32 s3, s3, 1
  s_cmp_gt_u32 s3, 20000
  s_cbranch_scc1 L_gn_17x
  buffer_load_dword v3, v2, s[28:31], 0 offen sc1
  s_waitcnt vmcnt(0)
  v_readfirstlane_b32 s1, v3
  s_nop 0
  s_cmp_eq_u32 s1, 0
  s_cbranch_scc1 L_gn_17
L_gn_17x:
  v_mov_b32 v2, 157680
  v_mov_b32 v3, s1
  ds_write_b32 v2, v3
  v_mov_b32 v60, v56
  v_mov_b32 v61, v57
  v_mov_b32 v56, s1
  v_mov_b32 v57, s1
  v_mov_b32 v62, s1
  v_mov_b32 v63, s1
  s_lshl_b32 s40, s72, 4
  s_add_u32 s40, s40, 196608
  v_mov_b32 v2, 0
  s_mov_b32 exec_lo, 0
  s_mov_b32 exec_hi, 0x80000000
  buffer_store_dwordx4 v[54:57], v2, s[12:15], s40 offen sc1
  buffer_store_dwordx4 v[60:63], v2, s[12:15], s40 offen offset:16 sc1
  s_mov_b64 exec, -1
  s_waitcnt lgkmcnt(0)
  s_barrier
  ds_read_b64_tr_b16 v[184:185], v132 offset:0
  ds_read_b64_tr_b16 v[186:187], v132 offset:512
  ds_read_b64_tr_b16 v[188:189], v133 offset:0
  ds_read_b64_tr_b16 v[190:191], v133 offset:512
  ds_read_b128 v[80:83], v124 offset:0
  ds_read_b128 v[84:87], v124 offset:4096
  ds_read_b64_tr_b16 v[192:193], v132 offset:2048
  ds_read_b64_tr_b16 v[194:195], v132 offset:2560
  ds_read_b64_tr_b16 v[196:197], v133 offset:2048
  ds_read_b64_tr_b16 v[198:199], v133 offset:2560
  ds_read_b128 v[88:91], v125 offset:0
  ds_read_b128 v[92:95], v125 offset:4096
  s_waitcnt lgkmcnt(6)
  v_mfma_f32_32x32x16_bf16 v[16:31], v[80:83], v[184:187], 0
  ds_read_b64_tr_b16 v[200:201], v132 offset:4096
  ds_read_b64_tr_b16 v[202:203], v132 offset:4608
  v_mfma_f32_32x32x16_bf16 v[32:47], v[80:83], v[188:191], 0
  ds_read_b64_tr_b16 v[204:205], v133 offset:4096
  ds_read_b64_tr_b16 v[206:207], v133 offset:4608
  v_mfma_f32_32x32x16_bf16 v[48:63], v[84:87], v[184:187], 0
  ds_read_b128 v[96:99], v126 offset:0
  ds_read_b128 v[100:103], v126 offset:4096
  v_mfma_f32_32x32x16_bf16 v[64:79], v[84:87], v[188:191], 0
  v_mfma_f32_16x16x32_bf16 v[112:115], v[184:187], v[120:123], 0
  v_mfma_f32_16x16x32_bf16 v[116:119], v[188:191], v[120:123], 0
  s_waitcnt lgkmcnt(6)
  v_mfma_f32_32x32x16_bf16 v[16:31], v[88:91], v[192:195], v[16:31]
  ds_read_b64_tr_b16 v[184:185], v132 offset:6144
  ds_read_b64_tr_b16 v[186:187], v132 offset:6656
  v_mfma_f32_32x32x16_bf16 v[32:47], v[88:91], v[196:199], v[32:47]
  ds_read_b64_tr_b16 v[188:189], v133 offset:6144
  ds_read_b64_tr_b16 v[190:191], v133 offset:6656
  v_mfma_f32_32x32x16_bf16 v[48:63], v[92:95], v[192:195], v[48:63]
  ds_read_b128 v[80:83], v127 offset:0
  ds_read_b128 v[84:87], v127 offset:4096
  v_mfma_f32_32x32x16_bf16 v[64:79], v[92:95], v[196:199], v[64:79]
  v_mfma_f32_16x16x32_bf16 v[112:115], v[192:195], v[120:123], v[112:115]
  v_mfma_f32_16x16x32_bf16 v[116:119], v[196:199], v[120:123], v[116:119]
  s_waitcnt lgkmcnt(0)
  v_mfma_f32_32x32x16_bf16 v[16:31], v[96:99], v[200:203], v[16:31]
  s_barrier
  ds_read_b64_tr_b16 v[192:193], v132 offset:32768
  ds_read_b64_tr_b16 v[194:195], v132 offset:33280
  v_mfma_f32_32x32x16_bf16 v[32:47], v[96:99], v[204:207], v[32:47]
  ds_read_b64_tr_b16 v[196:197], v133 offset:32768
  ds_read_b64_tr_b16 v[198:199], v133 offset:33280
  v_mfma_f32_32x32x16_bf16 v[48:63], v[100:103], v[200:203], v[48:63]
  ds_read_b128 v[88:91], v124 offset:32768
  ds_read_b128 v[92:95], v124 offset:36864
  v_mfma_f32_32x32x16_bf16 v[64:79], v[100:103], v[204:207], v[64:79]
  v_mfma_f32_16x16x32_bf16 v[112:115], v[200:203], v[236:239], v[112:115]
  v_mfma_f32_16x16x32_bf16 v[116:119], v[204:207], v[236:239], v[116:119]
  s_waitcnt lgkmcnt(6)
  v_mfma_f32_32x32x16_bf16 v[16:31], v[80:83], v[184:187], v[16:31]
  ds_read_b64_tr_b16 v[200:201], v132 offset:34816
  ds_read_b64_tr_b16 v[202:203], v132 offset:35328
  v_mfma_f32_32x32x16_bf16 v[32:47], v[80:83], v[188:191], v[32:47]
  ds_read_b64_tr_b16 v[204:205], v133 offset:34816
  ds_read_b64_tr_b16 v[206:207], v133 offset:35328
  v_mfma_f32_32x32x16_bf16 v[48:63], v[84:87], v[184:187], v[48:63]
  ds_read_b128 v[96:99], v125 offset:32768
  ds_read_b128 v[100:103], v125 offset:36864
  v_mfma_f32_32x32x16_bf16 v[64:79], v[84:87], v[188:191], v[64:79]
  v_mfma_f32_16x16x32_bf16 v[112:115], v[184:187], v[236:239], v[112:115]
  v_mfma_f32_16x16x32_bf16 v[116:119], v[188:191], v[236:239], v[116:119]
  s_waitcnt lgkmcnt(6)
  v_mfma_f32_32x32x16_bf16 v[16:31], v[88:91], v[192:195], v[16:31]
  s_and_b32 s40, s34, 7
  s_lshl_b32 s40, s40, 6
  s_lshl_b32 s41, s33, 4
  s_add_u32 s40, s40, s41
  s_mul_i32 s40, s40, s38
  s_lshl_b32 s41, s59, 1
  s_and_b32 s41, s41, 0xffffff80
  s_add_u32 s40, s40, s41
  v_lshrrev_b32 v2, 1, v1
  v_and_b32 v2, 15, v2
  v_mul_lo_u32 v2, v2, s38
  v_and_b32 v3, 1, v1
  v_lshlrev_b32 v3, 7, v3
  v_add_u32 v2, v2, v3
  s_mov_b32 exec_hi, 0
  buffer_load_dword v255, v2, s[8:11], s40 offen
  s_mov_b32 exec_hi, -1
  ds_read_b64_tr_b16 v[184:185], v132 offset:36864
  ds_read_b64_tr_b16 v[186:187], v132 offset:37376
  v_mfma_f32_32x32x16_bf16 v[32:47], v[88:91], v[196:199], v[32:47]
  ds_read_b64_tr_b16 v[188:189], v133 offset:36864
  ds_read_b64_tr_b16 v[190:191], v133 offset:37376
  v_mfma_f32_32x32x16_bf16 v[48:63], v[92:95], v[192:195], v[48:63]
  ds_read_b128 v[80:83], v126 offset:32768
  ds_read_b128 v[84:87], v126 offset:36864
  v_mfma_f32_32x32x16_bf16 v[64:79], v[92:95], v[196:199], v[64:79]
  s_waitcnt lgkmcnt(6)
  v_mfma_f32_32x32x16_bf16 v[16:31], v[96:99], v[200:203], v[16:31]
  v_and_b32 v2, 15, v1
  v_lshrrev_b32 v3, 4, v1
  v_cmp_gt_u32 vcc, 2, v2
  v_lshlrev_b32 v2, 6, v2
  v_lshlrev_b32 v3, 4, v3
  v_add_u32 v2, v2, v3
  s_lshr_b32 s40, s33, 1
  s_lshl_b32 s40, s40, 7
  s_add_u32 s40, s40, 157696
  v_add_u32 v2, s40, v2
  s_and_saveexec_b64 s[60:61], vcc
  ds_write_b128 v2, v[112:115] offset:0
  ds_write_b128 v2, v[116:119] offset:256
  s_mov_b64 exec, s[60:61]
  ds_read_b64_tr_b16 v[192:193], v132 offset:38912
  ds_read_b64_tr_b16 v[194:195], v132 offset:39424
  v_mfma_f32_32x32x16_bf16 v[32:47], v[96:99], v[204:207], v[32:47]
  ds_read_b64_tr_b16 v[196:197], v133 offset:38912
  ds_read_b64_tr_b16 v[198:199], v133 offset:39424
  v_mfma_f32_32x32x16_bf16 v[48:63], v[100:103], v[200:203], v[48:63]
  ds_read_b128 v[88:91], v127 offset:32768
  ds_read_b128 v[92:95], v127 offset:36864
  v_mfma_f32_32x32x16_bf16 v[64:79], v[100:103], v[204:207], v[64:79]
  s_waitcnt lgkmcnt(0)
  v_mfma_f32_32x32x16_bf16 v[16:31], v[80:83], v[184:187], v[16:31]
  s_barrier
  ds_read_b64_tr_b16 v[200:201], v134 offset:0
  ds_read_b64_tr_b16 v[202:203], v134 offset:512
  v_mfma_f32_32x32x16_bf16 v[32:47], v[80:83], v[188:191], v[32:47]
  ds_read_b64_tr_b16 v[204:205], v135 offset:0
  ds_read_b64_tr_b16 v[206:207], v135 offset:512
  v_mfma_f32_32x32x16_bf16 v[48:63], v[84:87], v[184:187], v[48:63]
  ds_read_b128 v[96:99], v128 offset:0
  ds_read_b128 v[100:103], v128 offset:4096
  v_mfma_f32_32x32x16_bf16 v[64:79], v[84:87], v[188:191], v[64:79]
  s_waitcnt lgkmcnt(6)
  v_mfma_f32_32x32x16_bf16 v[16:31], v[88:91], v[192:195], v[16:31]
  ds_read_b64_tr_b16 v[184:185], v134 offset:2048
  ds_read_b64_tr_b16 v[186:187], v134 offset:2560
  v_mfma_f32_32x32x16_bf16 v[32:47], v[88:91], v[196:199], v[32:47]
  ds_read_b64_tr_b16 v[188:189], v135 offset:2048
  ds_read_b64_tr_b16 v[190:191], v135 offset:2560
  v_mfma_f32_32x32x16_bf16 v[48:63], v[92:95], v[192:195], v[48:63]
  ds_read_b128 v[80:83], v129 offset:0
  ds_read_b128 v[84:87], v129 offset:4096
  v_mfma_f32_32x32x16_bf16 v[64:79], v[92:95], v[196:199], v[64:79]
  s_waitcnt lgkmcnt(6)
  v_mfma_f32_32x32x16_bf16 v[16:31], v[96:99], v[200:203], v[16:31]
  ds_read_b64_tr_b16 v[192:193], v134 offset:4096
  ds_read_b64_tr_b16 v[194:195], v134 offset:4608
  v_mfma_f32_32x32x16_bf16 v[32:47], v[96:99], v[204:207], v[32:47]
  ds_read_b64_tr_b16 v[196:197], v135 offset:4096
  ds_read_b64_tr_b16 v[198:199], v135 offset:4608
  v_mfma_f32_32x32x16_bf16 v[48:63], v[100:103], v[200:203], v[48:63]
  ds_read_b128 v[88:91], v130 offset:0
  ds_read_b128 v[92:95], v130 offset:4096
  v_mfma_f32_32x32x16_bf16 v[64:79], v[100:103], v[204:207], v[64:79]
  s_waitcnt lgkmcnt(6)
  v_mfma_f32_32x32x16_bf16 v[16:31], v[80:83], v[184:187], v[16:31]
  ds_read_b64_tr_b16 v[200:201], v134 offset:6144
  ds_read_b64_tr_b16 v[202:203], v134 offset:6656
  v_mfma_f32_32x32x16_bf16 v[32:47], v[80:83], v[188:191], v[32:47]
  ds_read_b64_tr_b16 v[204:205], v135 offset:6144
  ds_read_b64_tr_b16 v[206:207], v135 offset:6656
  v_mfma_f32_32x32x16_bf16 v[48:63], v[84:87], v[184:187], v[48:63]
  ds_read_b128 v[96:99], v131 offset:0
  ds_read_b128 v[100:103], v131 offset:4096
  v_mfma_f32_32x32x16_bf16 v[64:79], v[84:87], v[188:191], v[64:79]
  s_waitcnt lgkmcnt(0)
  v_mfma_f32_32x32x16_bf16 v[16:31], v[88:91], v[192:195], v[16:31]
  s_barrier
  ds_read_b64_tr_b16 v[184:185], v134 offset:32768
  ds_read_b64_tr_b16 v[186:187], v134 offset:33280
  v_mfma_f32_32x32x16_bf16 v[32:47], v[88:91], v[196:199], v[32:47]
  ds_read_b64_tr_b16 v[188:189], v135 offset:32768
  ds_read_b64_tr_b16 v[190:191], v135 offset:33280
  v_mfma_f32_32x32x16_bf16 v[48:63], v[92:95], v[192:195], v[48:63]
  ds_read_b128 v[80:83], v128 offset:32768
  ds_read_b128 v[84:87], v128 offset:36864
  v_mfma_f32_32x32x16_bf16 v[64:79], v[92:95], v[196:199], v[64:79]
  s_waitcnt lgkmcnt(6)
  v_mfma_f32_32x32x16_bf16 v[16:31], v[96:99], v[200:203], v[16:31]
  ds_read_b64_tr_b16 v[192:193], v134 offset:34816
  ds_read_b64_tr_b16 v[194:195], v134 offset:35328
  v_mfma_f32_32x32x16_bf16 v[32:47], v[96:99], v[204:207], v[32:47]
  ds_read_b64_tr_b16 v[196:197], v135 offset:34816
  ds_read_b64_tr_b16 v[198:199], v135 offset:35328
  v_mfma_f32_32x32x16_bf16 v[48:63], v[100:103], v[200:203], v[48:63]
  ds_read_b128 v[88:91], v129 offset:32768
  ds_read_b128 v[92:95], v129 offset:36864
  v_mfma_f32_32x32x16_bf16 v[64:79], v[100:103], v[204:207], v[64:79]
  s_waitcnt lgkmcnt(6)
  v_mfma_f32_32x32x16_bf16 v[16:31], v[80:83], v[184:187], v[16:31]
  ds_read_b64_tr_b16 v[200:201], v134 offset:36864
  ds_read_b64_tr_b16 v[202:203], v134 offset:37376
  v_mfma_f32_32x32x16_bf16 v[32:47], v[80:83], v[188:191], v[32:47]
  ds_read_b64_tr_b16 v[204:205], v135 offset:36864
  ds_read_b64_tr_b16 v[206:207], v135 offset:37376
  v_mfma_f32_32x32x16_bf16 v[48:63], v[84:87], v[184:187], v[48:63]
  ds_read_b128 v[96:99], v130 offset:32768
  ds_read_b128 v[100:103], v130 offset:36864
  v_mfma_f32_32x32x16_bf16 v[64:79], v[84:87], v[188:191], v[64:79]
  s_waitcnt lgkmcnt(6)
  v_mfma_f32_32x32x16_bf16 v[16:31], v[88:91], v[192:195], v[16:31]
  ds_read_b64_tr_b16 v[184:185], v134 offset:38912
  ds_read_b64_tr_b16 v[186:187], v134 offset:39424
  v_mfma_f32_32x32x16_bf16 v[32:47], v[88:91], v[196:199], v[32:47]
  ds_read_b64_tr_b16 v[188:189], v135 offset:38912
  ds_read_b64_tr_b16 v[190:191], v135 offset:39424
  v_mfma_f32_32x32x16_bf16 v[48:63], v[92:95], v[192:195], v[48:63]
  ds_read_b128 v[80:83], v131 offset:32768
  ds_read_b128 v[84:87], v131 offset:36864
  v_mfma_f32_32x32x16_bf16 v[64:79], v[92:95], v[196:199], v[64:79]
  s_waitcnt lgkmcnt(0)
  v_mfma_f32_32x32x16_bf16 v[16:31], v[96:99], v[200:203], v[16:31]
  s_barrier
  ds_read_b64_tr_b16 v[192:193], v132 offset:0
  ds_read_b64_tr_b16 v[194:195], v132 offset:512
  v_mfma_f32_32x32x16_bf16 v[32:47], v[96:99], v[204:207], v[32:47]
  ds_read_b64_tr_b16 v[196:197], v133 offset:0
  ds_read_b64_tr_b16 v[198:199], v133 offset:512
  v_mfma_f32_32x32x16_bf16 v[48:63], v[100:103], v[200:203], v[48:63]
  ds_read_b128 v[88:91], v124 offset:0
  ds_read_b128 v[92:95], v124 offset:4096
  v_mfma_f32_32x32x16_bf16 v[64:79], v[100:103], v[204:207], v[64:79]
  s_waitcnt lgkmcnt(6)
  v_mfma_f32_32x32x16_bf16 v[16:31], v[80:83], v[184:187], v[16:31]
  ds_read_b64_tr_b16 v[200:201], v132 offset:2048
  ds_read_b64_tr_b16 v[202:203], v132 offset:2560
  v_mfma_f32_32x32x16_bf16 v[32:47], v[80:83], v[188:191], v[32:47]
  ds_read_b64_tr_b16 v[204:205], v133 offset:2048
  ds_read_b64_tr_b16 v[206:207], v133 offset:2560
  v_mfma_f32_32x32x16_bf16 v[48:63], v[84:87], v[184:187], v[48:63]
  ds_read_b128 v[96:99], v125 offset:0
  ds_read_b128 v[100:103], v125 offset:4096
  v_mfma_f32_32x32x16_bf16 v[64:79], v[84:87], v[188:191], v[64:79]
  s_waitcnt lgkmcnt(6)
  v_mfma_f32_32x32x16_bf16 v[16:31], v[88:91], v[192:195], v[16:31]
  ds_read_b64_tr_b16 v[184:185], v132 offset:4096
  ds_read_b64_tr_b16 v[186:187], v132 offset:4608
  v_mfma_f32_32x32x16_bf16 v[32:47], v[88:91], v[196:199], v[32:47]
  ds_read_b64_tr_b16 v[188:189], v133 offset:4096
  ds_read_b64_tr_b16 v[190:191], v133 offset:4608
  v_mfma_f32_32x32x16_bf16 v[48:63], v[92:95], v[192:195], v[48:63]
  ds_read_b128 v[80:83], v126 offset:0
  ds_read_b128 v[84:87], v126 offset:4096
  v_mfma_f32_32x32x16_bf16 v[64:79], v[92:95], v[196:199], v[64:79]
  s_waitcnt lgkmcnt(6)
  v_mfma_f32_32x32x16_bf16 v[16:31], v[96:99], v[200:203], v[16:31]
  ds_read_b64_tr_b16 v[192:193], v132 offset:6144
  ds_read_b64_tr_b16 v[194:195], v132 offset:6656
  v_mfma_f32_32x32x16_bf16 v[32:47], v[96:99], v[204:207], v[32:47]
  ds_read_b64_tr_b16 v[196:197], v133 offset:6144
  ds_read_b64_tr_b16 v[198:199], v133 offset:6656
  v_mfma_f32_32x32x16_bf16 v[48:63], v[100:103], v[200:203], v[48:63]
  ds_read_b128 v[88:91], v127 offset:0
  ds_read_b128 v[92:95], v127 offset:4096
  v_mfma_f32_32x32x16_bf16 v[64:79], v[100:103], v[204:207], v[64:79]
  s_waitcnt lgkmcnt(0)
  v_mfma_f32_32x32x16_bf16 v[16:31], v[80:83], v[184:187], v[16:31]
  s_barrier
  ds_read_b64_tr_b16 v[200:201], v132 offset:32768
  ds_read_b64_tr_b16 v[202:203], v132 offset:33280
  v_mfma_f32_32x32x16_bf16 v[32:47], v[80:83], v[188:191], v[32:47]
  ds_read_b64_tr_b16 v[204:205], v133 offset:32768
  ds_read_b64_tr_b16 v[206:207], v133 offset:33280
  v_mfma_f32_32x32x16_bf16 v[48:63], v[84:87], v[184:187], v[48:63]
  ds_read_b128 v[96:99], v124 offset:32768
  ds_read_b128 v[100:103], v124 offset:36864
  v_mfma_f32_32x32x16_bf16 v[64:79], v[84:87], v[188:191], v[64:79]
  s_waitcnt lgkmcnt(6)
  v_mfma_f32_32x32x16_bf16 v[16:31], v[88:91], v[192:195], v[16:31]
  ds_read_b64_tr_b16 v[184:185], v132 offset:34816
  ds_read_b64_tr_b16 v[186:187], v132 offset:35328
  v_mfma_f32_32x32x16_bf16 v[32:47], v[88:91], v[196:199], v[32:47]
  ds_read_b64_tr_b16 v[188:189], v133 offset:34816
  ds_read_b64_tr_b16 v[190:191], v133 offset:35328
  v_mfma_f32_32x32x16_bf16 v[48:63], v[92:95], v[192:195], v[48:63]
  ds_read_b128 v[80:83], v125 offset:32768
  ds_read_b128 v[84:87], v125 offset:36864
  v_mfma_f32_32x32x16_bf16 v[64:79], v[92:95], v[196:199], v[64:79]
  s_waitcnt lgkmcnt(6)
  v_mfma_f32_32x32x16_bf16 v[16:31], v[96:99], v[200:203], v[16:31]
  ds_read_b64_tr_b16 v[192:193], v132 offset:36864
  ds_read_b64_tr_b16 v[194:195], v132 offset:37376
  v_mfma_f32_32x32x16_bf16 v[32:47], v[96:99], v[204:207], v[32:47]
  ds_read_b64_tr_b16 v[196:197], v133 offset:36864
  ds_read_b64_tr_b16 v[198:199], v133 offset:37376
  v_mfma_f32_32x32x16_bf16 v[48:63], v[100:103], v[200:203], v[48:63]
  ds_read_b128 v[88:91], v126 offset:32768
  ds_read_b128 v[92:95], v126 offset:36864
  v_mfma_f32_32x32x16_bf16 v[64:79], v[100:103], v[204:207], v[64:79]
  s_waitcnt lgkmcnt(6)
  v_mfma_f32_32x32x16_bf16 v[16:31], v[80:83], v[184:187], v[16:31]
  ds_read_b64_tr_b16 v[200:201], v132 offset:38912
  ds_read_b64_tr_b16 v[202:203], v132 offset:39424
  v_mfma_f32_32x32x16_bf16 v[32:47], v[80:83], v[188:191], v[32:47]
  ds_read_b64_tr_b16 v[204:205], v133 offset:38912
  ds_read_b64_tr_b16 v[206:207], v133 offset:39424
  v_mfma_f32_32x32x16_bf16 v[48:63], v[84:87], v[184:187], v[48:63]
  ds_read_b128 v[96:99], v127 offset:32768
  ds_read_b128 v[100:103], v127 offset:36864
  v_mfma_f32_32x32x16_bf16 v[64:79], v[84:87], v[188:191], v[64:79]
  s_waitcnt lgkmcnt(0)
  v_mfma_f32_32x32x16_bf16 v[16:31], v[88:91], v[192:195], v[16:31]
  s_barrier
  ds_read_b64_tr_b16 v[184:185], v134 offset:0
  ds_read_b64_tr_b16 v[186:187], v134 offset:512
  v_mfma_f32_32x32x16_bf16 v[32:47], v[88:91], v[196:199], v[32:47]
  ds_read_b64_tr_b16 v[188:189], v135 offset:0
  ds_read_b64_tr_b16 v[190:191], v135 offset:512
  v_mfma_f32_32x32x16_bf16 v[48:63], v[92:95], v[192:195], v[48:63]
  ds_read_b128 v[80:83], v128 offset:0
  ds_read_b128 v[84:87], v128 offset:4096
  v_mfma_f32_32x32x16_bf16 v[64:79], v[92:95], v[196:199], v[64:79]
  s_waitcnt lgkmcnt(6)
  v_mfma_f32_32x32x16_bf16 v[16:31], v[96:99], v[200:203], v[16:31]
  ds_read_b64_tr_b16 v[192:193], v134 offset:2048
  ds_read_b64_tr_b16 v[194:195], v134 offset:2560
  v_mfma_f32_32x32x16_bf16 v[32:47], v[96:99], v[204:207], v[32:47]
  ds_read_b64_tr_b16 v[196:197], v135 offset:2048
  ds_read_b64_tr_b16 v[198:199], v135 offset:2560
  v_mfma_f32_32x32x16_bf16 v[48:63], v[100:103], v[200:203], v[48:63]
  ds_read_b128 v[88:91], v129 offset:0
  ds_read_b128 v[92:95], v129 offset:4096
  v_mfma_f32_32x32x16_bf16 v[64:79], v[100:103], v[204:207], v[64:79]
  s_waitcnt lgkmcnt(6)
  v_mfma_f32_32x32x16_bf16 v[16:31], v[80:83], v[184:187], v[16:31]
  ds_read_b64_tr_b16 v[200:201], v134 offset:4096
  ds_read_b64_tr_b16 v[202:203], v134 offset:4608
  v_mfma_f32_32x32x16_bf16 v[32:47], v[80:83], v[188:191], v[32:47]
  ds_read_b64_tr_b16 v[204:205], v135 offset:4096
  ds_read_b64_tr_b16 v[206:207], v135 offset:4608
  v_mfma_f32_32x32x16_bf16 v[48:63], v[84:87], v[184:187], v[48:63]
  ds_read_b128 v[96:99], v130 offset:0
  ds_read_b128 v[100:103], v130 offset:4096
  v_mfma_f32_32x32x16_bf16 v[64:79], v[84:87], v[188:191], v[64:79]
  s_waitcnt lgkmcnt(6)
  v_mfma_f32_32x32x16_bf16 v[16:31], v[88:91], v[192:195], v[16:31]
  ds_read_b64_tr_b16 v[184:185], v134 offset:6144
  ds_read_b64_tr_b16 v[186:187], v134 offset:6656
  v_mfma_f32_32x32x16_bf16 v[32:47], v[88:91], v[196:199], v[32:47]
  ds_read_b64_tr_b16 v[188:189], v135 offset:6144
  ds_read_b64_tr_b16 v[190:191], v135 offset:6656
  v_mfma_f32_32x32x16_bf16 v[48:63], v[92:95], v[192:195], v[48:63]
  ds_read_b128 v[80:83], v131 offset:0
  ds_read_b128 v[84:87], v131 offset:4096
  v_mfma_f32_32x32x16_bf16 v[64:79], v[92:95], v[196:199], v[64:79]
  s_waitcnt lgkmcnt(0)
  v_mfma_f32_32x32x16_bf16 v[16:31], v[96:99], v[200:203], v[16:31]
  s_barrier
  ds_read_b64_tr_b16 v[192:193], v134 offset:32768
  ds_read_b64_tr_b16 v[194:195], v134 offset:33280
  v_mfma_f32_32x32x16_bf16 v[32:47], v[96:99], v[204:207], v[32:47]
  ds_read_b64_tr_b16 v[196:197], v135 offset:32768
  ds_read_b64_tr_b16 v[198:199], v135 offset:33280
  v_mfma_f32_32x32x16_bf16 v[48:63], v[100:103], v[200:203], v[48:63]
  ds_read_b128 v[88:91], v128 offset:32768
  ds_read_b128 v[92:95], v128 offset:36864
  v_mfma_f32_32x32x16_bf16 v[64:79], v[100:103], v[204:207], v[64:79]
  s_waitcnt lgkmcnt(6)
  v_mfma_f32_32x32x16_bf16 v[16:31], v[80:83], v[184:187], v[16:31]
  ds_read_b64_tr_b16 v[200:201], v134 offset:34816
  ds_read_b64_tr_b16 v[202:203], v134 offset:35328
  v_mfma_f32_32x32x16_bf16 v[32:47], v[80:83], v[188:191], v[32:47]
  ds_read_b64_tr_b16 v[204:205], v135 offset:34816
  ds_read_b64_tr_b16 v[206:207], v135 offset:35328
  v_mfma_f32_32x32x16_bf16 v[48:63], v[84:87], v[184:187], v[48:63]
  ds_read_b128 v[96:99], v129 offset:32768
  ds_read_b128 v[100:103], v129 offset:36864
  v_mfma_f32_32x32x16_bf16 v[64:79], v[84:87], v[188:191], v[64:79]
  s_waitcnt lgkmcnt(6)
  v_mfma_f32_32x32x16_bf16 v[16:31], v[88:91], v[192:195], v[16:31]
  ds_read_b64_tr_b16 v[184:185], v134 offset:36864
  ds_read_b64_tr_b16 v[186:187], v134 offset:37376
  v_mfma_f32_32x32x16_bf16 v[32:47], v[88:91], v[196:199], v[32:47]
  ds_read_b64_tr_b16 v[188:189], v135 offset:36864
  ds_read_b64_tr_b16 v[190:191], v135 offset:37376
  v_mfma_f32_32x32x16_bf16 v[48:63], v[92:95], v[192:195], v[48:63]
  ds_read_b128 v[80:83], v130 offset:32768
  ds_read_b128 v[84:87], v130 offset:36864
  v_mfma_f32_32x32x16_bf16 v[64:79], v[92:95], v[196:199], v[64:79]
  s_waitcnt lgkmcnt(6)
  v_mfma_f32_32x32x16_bf16 v[16:31], v[96:99], v[200:203], v[16:31]
  ds_read_b64_tr_b16 v[192:193], v134 offset:38912
  ds_read_b64_tr_b16 v[194:195], v134 offset:39424
  v_mfma_f32_32x32x16_bf16 v[32:47], v[96:99], v[204:207], v[32:47]
  ds_read_b64_tr_b16 v[196:197], v135 offset:38912
  ds_read_b64_tr_b16 v[198:199], v135 offset:39424
  v_mfma_f32_32x32x16_bf16 v[48:63], v[100:103], v[200:203], v[48:63]
  ds_read_b128 v[88:91], v131 offset:32768
  ds_read_b128 v[92:95], v131 offset:36864
  v_mfma_f32_32x32x16_bf16 v[64:79], v[100:103], v[204:207], v[64:79]
  s_waitcnt lgkmcnt(0)
  v_mfma_f32_32x32x16_bf16 v[16:31], v[80:83], v[184:187], v[16:31]
  v_mfma_f32_32x32x16_bf16 v[32:47], v[80:83], v[188:191], v[32:47]
  v_mfma_f32_32x32x16_bf16 v[48:63], v[84:87], v[184:187], v[48:63]
  v_mfma_f32_32x32x16_bf16 v[64:79], v[84:87], v[188:191], v[64:79]
  s_waitcnt lgkmcnt(0)
  v_mfma_f32_32x32x16_bf16 v[16:31], v[88:91], v[192:195], v[16:31]
  v_mfma_f32_32x32x16_bf16 v[32:47], v[88:91], v[196:199], v[32:47]
  v_mfma_f32_32x32x16_bf16 v[48:63], v[92:95], v[192:195], v[48:63]
  v_mfma_f32_32x32x16_bf16 v[64:79], v[92:95], v[196:199], v[64:79]
L_Aepi1:
  s_barrier
  s_and_b32 s40, s33, 1
  s_lshr_b32 s41, s33, 1
  v_and_b32 v2, 31, v1
  v_lshlrev_b32 v2, 2, v2
  s_lshl_b32 s42, s41, 7
  s_add_u32 s42, s42, 156672
  v_add_u32 v2, s42, v2
  ds_read_b32 v168, v2
  ds_read_b32 v169, v2 offset:256
  v_lshrrev_b32 v3, 5, v1
  v_lshlrev_b32 v3, 4, v3
  s_lshl_b32 s42, s40, 8
  s_add_u32 s42, s42, 155648
  v_add_u32 v228, s42, v3
  v_mov_b32 v210, 0
  ds_read_b128 v[136:139], v228 offset:0
  ds_read_b128 v[144:147], v228 offset:512
  ds_read_b128 v[140:143], v228 offset:32
  ds_read_b128 v[148:151], v228 offset:544
  ds_read_b128 v[152:155], v228 offset:64
  ds_read_b128 v[160:163], v228 offset:576
  ds_read_b128 v[156:159], v228 offset:96
  ds_read_b128 v[164:167], v228 offset:608
  s_waitcnt lgkmcnt(4)
  v_mul_f32 v170, v144, v169
  v_mul_f32 v171, v145, v169
  v_mul_f32 v172, v146, v169
  v_mul_f32 v173, v147, v169
  v_mul_f32 v174, v148, v169
  v_mul_f32 v175, v149, v169
  v_mul_f32 v176, v150, v169
  v_mul_f32 v177, v151, v169
  v_fma_f32 v32, v32, v136, v170
  v_fma_f32 v33, v33, v137, v171
  v_fma_f32 v34, v34, v138, v172
  v_fma_f32 v35, v35, v139, v173
  v_fma_f32 v36, v36, v140, v174
  v_fma_f32 v37, v37, v141, v175
  v_fma_f32 v38, v38, v142, v176
  v_fma_f32 v39, v39, v143, v177
  v_cvt_pk_bf16_f32 v194, v32, v33
  v_cvt_pk_bf16_f32 v195, v34, v35
  v_cvt_pk_bf16_f32 v196, v36, v37
  v_cvt_pk_bf16_f32 v197, v38, v39
  s_lshl_b32 s42, s63, 7
  s_lshr_b32 s41, s2, 3
  s_and_b32 s41, s41, 7
  s_mul_i32 s43, s41, 224
  s_mul_i32 s44, s33, 56
  s_add_u32 s43, s43, s44
  s_lshl_b32 s43, s43, 10
  s_add_u32 s43, s43, s42
  v_min_u32 v2, 55, v1
  v_lshlrev_b32 v2, 10, v2
  buffer_load_dword v255, v2, s[16:19], s43 offen
  s_lshl_b32 s43, s41, 6
  s_lshl_b32 s44, s33, 4
  s_add_u32 s43, s43, s44
  s_lshl_b32 s43, s43, 10
  s_add_u32 s43, s43, s42
  v_and_b32 v2, 15, v1
  v_lshlrev_b32 v2, 10, v2
  s_mov_b64 exec, 0xffff
  buffer_load_dword v255, v2, s[20:23], s43 offen
  s_mov_b64 exec, -1
  v_mul_f32 v170, v144, v168
  v_mul_f32 v171, v145, v168
  v_mul_f32 v172, v146, v168
  v_mul_f32 v173, v147, v168
  v_mul_f32 v174, v148, v168
  v_mul_f32 v175, v149, v168
  v_mul_f32 v176, v150, v168
  v_mul_f32 v177, v151, v168
  v_fma_f32 v16, v16, v136, v170
  v_fma_f32 v17, v17, v137, v171
  v_fma_f32 v18, v18, v138, v172
  v_fma_f32 v19, v19, v139, v173
  v_fma_f32 v20, v20, v140, v174
  v_fma_f32 v21, v21, v141, v175
  v_fma_f32 v22, v22, v142, v176
  v_fma_f32 v23, v23, v143, v177
  v_min_f32 v170, 0, v16
  v_min_f32 v171, 0, v17
  v_min_f32 v172, 0, v18
  v_min_f32 v173, 0, v19
  v_min_f32 v174, 0, v20
  v_min_f32 v175, 0, v21
  v_min_f32 v176, 0, v22
  v_min_f32 v177, 0, v23
  v_exp_f32 v170, v170
  v_exp_f32 v171, v171
  v_exp_f32 v172, v172
  v_exp_f32 v173, v173
  v_exp_f32 v174, v174
  v_exp_f32 v175, v175
  v_exp_f32 v176, v176
  v_exp_f32 v177, v177
  v_max_f32 v16, s71, v16
  v_max_f32 v17, s71, v17
  v_max_f32 v18, s71, v18
  v_max_f32 v19, s71, v19
  v_max_f32 v20, s71, v20
  v_max_f32 v21, s71, v21
  v_max_f32 v22, s71, v22
  v_max_f32 v23, s71, v23
  v_fma_f32 v16, v16, s70, v170
  v_fma_f32 v17, v17, s70, v171
  v_fma_f32 v18, v18, s70, v172
  v_fma_f32 v19, v19, s70, v173
  v_fma_f32 v20, v20, s70, v174
  v_fma_f32 v21, v21, s70, v175
  v_fma_f32 v22, v22, s70, v176
  v_fma_f32 v23, v23, s70, v177
  v_add_f32 v210, v210, v16
  v_add_f32 v210, v210, v17
  v_add_f32 v210, v210, v18
  v_add_f32 v210, v210, v19
  v_add_f32 v210, v210, v20
  v_add_f32 v210, v210, v21
  v_add_f32 v210, v210, v22
  v_add_f32 v210, v210, v23
  v_cvt_pk_bf16_f32 v178, v16, v17
  v_cvt_pk_bf16_f32 v179, v18, v19
  v_cvt_pk_bf16_f32 v180, v20, v21
  v_cvt_pk_bf16_f32 v181, v22, v23
  s_nop 1
  v_mfma_f32_32x32x16_bf16 v[212:227], v[178:181], v[194:197], 0
  ds_read_b128 v[136:139], v228 offset:128
  ds_read_b128 v[144:147], v228 offset:640
  ds_read_b128 v[140:143], v228 offset:160
  ds_read_b128 v[148:151], v228 offset:672
  s_waitcnt lgkmcnt(4)
  v_mul_f32 v170, v160, v169
  v_mul_f32 v171, v161, v169
  v_mul_f32 v172, v162, v169
  v_mul_f32 v173, v163, v169
  v_mul_f32 v174, v164, v169
  v_mul_f32 v175, v165, v169
  v_mul_f32 v176, v166, v169
  v_mul_f32 v177, v167, v169
  v_fma_f32 v40, v40, v152, v170
  v_fma_f32 v41, v41, v153, v171
  v_fma_f32 v42, v42, v154, v172
  v_fma_f32 v43, v43, v155, v173
  v_fma_f32 v44, v44, v156, v174
  v_fma_f32 v45, v45, v157, v175
  v_fma_f32 v46, v46, v158, v176
  v_fma_f32 v47, v47, v159, v177
  v_cvt_pk_bf16_f32 v198, v40, v41
  v_cvt_pk_bf16_f32 v199, v42, v43
  v_cvt_pk_bf16_f32 v200, v44, v45
  v_cvt_pk_bf16_f32 v201, v46, v47
  v_mul_f32 v170, v160, v168
  v_mul_f32 v171, v161, v168
  v_mul_f32 v172, v162, v168
  v_mul_f32 v173, v163, v168
  v_mul_f32 v174, v164, v168
  v_mul_f32 v175, v165, v168
  v_mul_f32 v176, v166, v168
  v_mul_f32 v177, v167, v168
  v_fma_f32 v24, v24, v152, v170
  v_fma_f32 v25, v25, v153, v171
  v_fma_f32 v26, v26, v154, v172
  v_fma_f32 v27, v27, v155, v173
  v_fma_f32 v28, v28, v156, v174
  v_fma_f32 v29, v29, v157, v175
  v_fma_f32 v30, v30, v158, v176
  v_fma_f32 v31, v31, v159, v177
  v_min_f32 v170, 0, v24
  v_min_f32 v171, 0, v25
  v_min_f32 v172, 0, v26
  v_min_f32 v173, 0, v27
  v_min_f32 v174, 0, v28
  v_min_f32 v175, 0, v29
  v_min_f32 v176, 0, v30
  v_min_f32 v177, 0, v31
  v_exp_f32 v170, v170
  v_exp_f32 v171, v171
  v_exp_f32 v172, v172
  v_exp_f32 v173, v173
  v_exp_f32 v174, v174
  v_exp_f32 v175, v175
  v_exp_f32 v176, v176
  v_exp_f32 v177, v177
  v_max_f32 v24, s71, v24
  v_max_f32 v25, s71, v25
  v_max_f32 v26, s71, v26
  v_max_f32 v27, s71, v27
  v_max_f32 v28, s71, v28
  v_max_f32 v29, s71, v29
  v_max_f32 v30, s71, v30
  v_max_f32 v31, s71, v31
  v_fma_f32 v24, v24, s70, v170
  v_fma_f32 v25, v25, s70, v171
  v_fma_f32 v26, v26, s70, v172
  v_fma_f32 v27, v27, s70, v173
  v_fma_f32 v28, v28, s70, v174
  v_fma_f32 v29, v29, s70, v175
  v_fma_f32 v30, v30, s70, v176
  v_fma_f32 v31, v31, s70, v177
  v_add_f32 v210, v210, v24
  v_add_f32 v210, v210, v25
  v_add_f32 v210, v210, v26
  v_add_f32 v210, v210, v27
  v_add_f32 v210, v210, v28
  v_add_f32 v210, v210, v29
  v_add_f32 v210, v210, v30
  v_add_f32 v210, v210, v31
  v_cvt_pk_bf16_f32 v182, v24, v25
  v_cvt_pk_bf16_f32 v183, v26, v27
  v_cvt_pk_bf16_f32 v184, v28, v29
  v_cvt_pk_bf16_f32 v185, v30, v31
  s_nop 1
  v_mfma_f32_32x32x16_bf16 v[212:227], v[182:185], v[198:201], v[212:227]
  ds_read_b128 v[152:155], v228 offset:192
  ds_read_b128 v[160:163], v228 offset:704
  ds_read_b128 v[156:159], v228 offset:224
  ds_read_b128 v[164:167], v228 offset:736
  s_waitcnt lgkmcnt(4)
  v_mul_f32 v170, v144, v169
  v_mul_f32 v171, v145, v169
  v_mul_f32 v172, v146, v169
  v_mul_f32 v173, v147, v169
  v_mul_f32 v174, v148, v169
  v_mul_f32 v175, v149, v169
  v_mul_f32 v176, v150, v169
  v_mul_f32 v177, v151, v169
  v_fma_f32 v64, v64, v136, v170
  v_fma_f32 v65, v65, v137, v171
  v_fma_f32 v66, v66, v138, v172
  v_fma_f32 v67, v67, v139, v173
  v_fma_f32 v68, v68, v140, v174
  v_fma_f32 v69, v69, v141, v175
  v_fma_f32 v70, v70, v142, v176
  v_fma_f32 v71, v71, v143, v177
  v_cvt_pk_bf16_f32 v202, v64, v65
  v_cvt_pk_bf16_f32 v203, v66, v67
  v_cvt_pk_bf16_f32 v204, v68, v69
  v_cvt_pk_bf16_f32 v205, v70, v71
  v_mul_f32 v170, v144, v168
  v_mul_f32 v171, v145, v168
  v_mul_f32 v172, v146, v168
  v_mul_f32 v173, v147, v168
  v_mul_f32 v174, v148, v168
  v_mul_f32 v175, v149, v168
  v_mul_f32 v176, v150, v168
  v_mul_f32 v177, v151, v168
  v_fma_f32 v48, v48, v136, v170
  v_fma_f32 v49, v49, v137, v171
  v_fma_f32 v50, v50, v138, v172
  v_fma_f32 v51, v51, v139, v173
  v_fma_f32 v52, v52, v140, v174
  v_fma_f32 v53, v53, v141, v175
  v_fma_f32 v54, v54, v142, v176
  v_fma_f32 v55, v55, v143, v177
  v_min_f32 v170, 0, v48
  v_min_f32 v171, 0, v49
  v_min_f32 v172, 0, v50
  v_min_f32 v173, 0, v51
  v_min_f32 v174, 0, v52
  v_min_f32 v175, 0, v53
  v_min_f32 v176, 0, v54
  v_min_f32 v177, 0, v55
  v_exp_f32 v170, v170
  v_exp_f32 v171, v171
  v_exp_f32 v172, v172
  v_exp_f32 v173, v173
  v_exp_f32 v174, v174
  v_exp_f32 v175, v175
  v_exp_f32 v176, v176
  v_exp_f32 v177, v177
  v_max_f32 v48, s71, v48
  v_max_f32 v49, s71, v49
  v_max_f32 v50, s71, v50
  v_max_f32 v51, s71, v51
  v_max_f32 v52, s71, v52
  v_max_f32 v53, s71, v53
  v_max_f32 v54, s71, v54
  v_max_f32 v55, s71, v55
  v_fma_f32 v48, v48, s70, v170
  v_fma_f32 v49, v49, s70, v171
  v_fma_f32 v50, v50, s70, v172
  v_fma_f32 v51, v51, s70, v173
  v_fma_f32 v52, v52, s70, v174
  v_fma_f32 v53, v53, s70, v175
  v_fma_f32 v54, v54, s70, v176
  v_fma_f32 v55, v55, s70, v177
  v_add_f32 v210, v210, v48
  v_add_f32 v210, v210, v49
  v_add_f32 v210, v210, v50
  v_add_f32 v210, v210, v51
  v_add_f32 v210, v210, v52
  v_add_f32 v210, v210, v53
  v_add_f32 v210, v210, v54
  v_add_f32 v210, v210, v55
  v_cvt_pk_bf16_f32 v186, v48, v49
  v_cvt_pk_bf16_f32 v187, v50, v51
  v_cvt_pk_bf16_f32 v188, v52, v53
  v_cvt_pk_bf16_f32 v189, v54, v55
  s_nop 1
  v_mfma_f32_32x32x16_bf16 v[212:227], v[186:189], v[202:205], v[212:227]
  s_waitcnt lgkmcnt(0)
  v_mul_f32 v170, v160, v169
  v_mul_f32 v171, v161, v169
  v_mul_f32 v172, v162, v169
  v_mul_f32 v173, v163, v169
  v_mul_f32 v174, v164, v169
  v_mul_f32 v175, v165, v169
  v_mul_f32 v176, v166, v169
  v_mul_f32 v177, v167, v169
  v_fma_f32 v72, v72, v152, v170
  v_fma_f32 v73, v73, v153, v171
  v_fma_f32 v74, v74, v154, v172
  v_fma_f32 v75, v75, v155, v173
  v_fma_f32 v76, v76, v156, v174
  v_fma_f32 v77, v77, v157, v175
  v_fma_f32 v78, v78, v158, v176
  v_fma_f32 v79, v79, v159, v177
  v_cvt_pk_bf16_f32 v206, v72, v73
  v_cvt_pk_bf16_f32 v207, v74, v75
  v_cvt_pk_bf16_f32 v208, v76, v77
  v_cvt_pk_bf16_f32 v209, v78, v79
  v_mul_f32 v170, v160, v168
  v_mul_f32 v171, v161, v168
  v_mul_f32 v172, v162, v168
  v_mul_f32 v173, v163, v168
  v_mul_f32 v174, v164, v168
  v_mul_f32 v175, v165, v168
  v_mul_f32 v176, v166, v168
  v_mul_f32 v177, v167, v168
  v_fma_f32 v56, v56, v152, v170
  v_fma_f32 v57, v57, v153, v171
  v_fma_f32 v58, v58, v154, v172
  v_fma_f32 v59, v59, v155, v173
  v_fma_f32 v60, v60, v156, v174
  v_fma_f32 v61, v61, v157, v175
  v_fma_f32 v62, v62, v158, v176
  v_fma_f32 v63, v63, v159, v177
  v_min_f32 v170, 0, v56
  v_min_f32 v171, 0, v57
  v_min_f32 v172, 0, v58
  v_min_f32 v173, 0, v59
  v_min_f32 v174, 0, v60
  v_min_f32 v175, 0, v61
  v_min_f32 v176, 0, v62
  v_min_f32 v177, 0, v63
  v_exp_f32 v170, v170
  v_exp_f32 v171, v171
  v_exp_f32 v172, v172
  v_exp_f32 v173, v173
  v_exp_f32 v174, v174
  v_exp_f32 v175, v175
  v_exp_f32 v176, v176
  v_exp_f32 v177, v177
  v_max_f32 v56, s71, v56
  v_max_f32 v57, s71, v57
  v_max_f32 v58, s71, v58
  v_max_f32 v59, s71, v59
  v_max_f32 v60, s71, v60
  v_max_f32 v61, s71, v61
  v_max_f32 v62, s71, v62
  v_max_f32 v63, s71, v63
  v_fma_f32 v56, v56, s70, v170
  v_fma_f32 v57, v57, s70, v171
  v_fma_f32 v58, v58, s70, v172
  v_fma_f32 v59, v59, s70, v173
  v_fma_f32 v60, v60, s70, v174
  v_fma_f32 v61, v61, s70, v175
  v_fma_f32 v62, v62, s70, v176
  v_fma_f32 v63, v63, s70, v177
  v_add_f32 v210, v210, v56
  v_add_f32 v210, v210, v57
  v_add_f32 v210, v210, v58
  v_add_f32 v210, v210, v59
  v_add_f32 v210, v210, v60
  v_add_f32 v210, v210, v61
  v_add_f32 v210, v210, v62
  v_add_f32 v210, v210, v63
  v_cvt_pk_bf16_f32 v190, v56, v57
  v_cvt_pk_bf16_f32 v191, v58, v59
  v_cvt_pk_bf16_f32 v192, v60, v61
  v_cvt_pk_bf16_f32 v193, v62, v63
  s_nop 1
  v_mfma_f32_32x32x16_bf16 v[212:227], v[190:193], v[206:209], v[212:227]
  v_mov_b32 v170, v210
  s_nop 1
  v_permlane32_swap_b32 v170, v210
  v_add_f32 v210, v210, v170
  s_mov_b32 s56, 0xffff0000
  s_mov_b32 s57, 0xffff0000
  s_nop 4
  v_cndmask_b32 v170, v212, v220, s[56:57]
  v_cndmask_b32 v171, v213, v221, s[56:57]
  v_cndmask_b32 v172, v214, v222, s[56:57]
  v_cndmask_b32 v173, v215, v223, s[56:57]
  v_cndmask_b32 v174, v216, v224, s[56:57]
  v_cndmask_b32 v175, v217, v225, s[56:57]
  v_cndmask_b32 v176, v218, v226, s[56:57]
  v_cndmask_b32 v177, v219, v227, s[56:57]
  s_lshl_b32 s42, s35, 1
  s_lshr_b32 s41, s33, 1
  s_add_u32 s72, s42, s41
  s_lshl_b32 s42, s72, 12
  s_add_u32 s55, s42, 65536
  v_lshlrev_b32 v229, 2, v1
  buffer_atomic_add_f32 v170, v229, s[12:15], s55 offen offset:0
  buffer_atomic_add_f32 v171, v229, s[12:15], s55 offen offset:256
  buffer_atomic_add_f32 v172, v229, s[12:15], s55 offen offset:512
  buffer_atomic_add_f32 v173, v229, s[12:15], s55 offen offset:768
  buffer_atomic_add_f32 v174, v229, s[12:15], s55 offen offset:1024
  buffer_atomic_add_f32 v175, v229, s[12:15], s55 offen offset:1280
  buffer_atomic_add_f32 v176, v229, s[12:15], s55 offen offset:1536
  buffer_atomic_add_f32 v177, v229, s[12:15], s55 offen offset:1792
  v_lshrrev_b32 v2, 3, v1
  v_and_b32 v2, 1, v2
  v_lshlrev_b32 v2, 2, v2
  v_and_b32 v3, 3, v1
  v_add_u32 v2, v2, v3
  v_lshlrev_b32 v2, 8, v2
  v_lshrrev_b32 v3, 4, v1
  v_and_b32 v3, 1, v3
  v_lshlrev_b32 v3, 1, v3
  v_lshrrev_b32 v4, 2, v1
  v_and_b32 v4, 1, v4
  v_add_u32 v3, v3, v4
  v_lshlrev_b32 v3, 2, v3
  v_add_u32 v2, v2, v3
  s_mov_b32 exec_hi, 0
  buffer_atomic_add_f32 v210, v2, s[12:15], s55 offen offset:2048
  s_mov_b32 exec_hi, -1
  s_lshl_b32 s40, s72, 7
  s_add_u32 s40, s40, 12288
  v_mov_b32 v2, 0
  v_mov_b32 v3, 1
  s_waitcnt vmcnt(0)
  s_mov_b64 exec, 1
  buffer_atomic_add v3, v2, s[12:15], s40 offen sc1
  s_mov_b64 exec, -1
L_P2:
L_P2loop:
  s_add_u32 m0, s67, 0
  s_nop 0
  buffer_load_dwordx4 v251, s[16:19], s73 offen lds
  buffer_load_dwordx4 v249, s[16:19], s73 offen offset:1024 lds
  s_add_u32 m0, s67, 2048
  s_add_u32 s40, s73, 16384
  buffer_load_dwordx4 v251, s[16:19], s40 offen lds
  buffer_load_dwordx4 v249, s[16:19], s40 offen offset:1024 lds
  s_add_u32 m0, s67, 4096
  s_nop 0
  buffer_load_dwordx4 v251, s[16:19], s74 offen lds
  buffer_load_dwordx4 v249, s[16:19], s74 offen offset:1024 lds
  s_add_u32 m0, s67, 6144
  s_add_u32 s40, s74, 16384
  buffer_load_dwordx4 v251, s[16:19], s40 offen lds
  buffer_load_dwordx4 v249, s[16:19], s40 offen offset:1024 lds
  s_add_u32 m0, s67, 8192
  s_nop 0
  buffer_load_dwordx4 v251, s[16:19], s75 offen lds
  buffer_load_dwordx4 v249, s[16:19], s75 offen offset:1024 lds
  s_add_u32 m0, s67, 10240
  s_add_u32 s40, s75, 16384
  buffer_load_dwordx4 v251, s[16:19], s40 offen lds
  buffer_load_dwordx4 v249, s[16:19], s40 offen offset:1024 lds
  s_lshl_b32 s40, s62, 6
  s_lshr_b32 s41, s33, 1
  s_lshl_b32 s41, s41, 5
  s_add_u32 s40, s40, s41
  s_lshl_b32 s40, s40, 10
  s_lshl_b32 s41, s63, 7
  s_add_u32 s40, s40, s41
  s_and_b32 s41, s33, 1
  s_lshl_b32 s41, s41, 6
  s_add_u32 s40, s40, s41
  buffer_load_dwordx4 v[240:243], v254, s[4:7], s40 offen offset:0
  buffer_load_dwordx4 v[244:247], v254, s[4:7], s40 offen offset:32
  v_add_u32 v236, s96, v248
  v_xor_b32 v237, 64, v236
  s_cmp_lg_u32 s33, 0
  s_cbranch_scc1 L_rp_18e
  s_lshl_b32 s43, s62, 7
  s_add_u32 s43, s43, 0
  s_add_u32 s94, s92, s43
  s_addc_u32 s95, s93, 0
  s_mov_b32 s3, 0
L_rp_18:
  s_load_dwordx16 s[76:91], s[94:95], 0 glc
  s_waitcnt lgkmcnt(0)
  s_xor_b32 s76, s76, s1
  s_xor_b32 s77, s77, s1
  s_xor_b32 s78, s78, s1
  s_xor_b32 s79, s79, s1
  s_xor_b32 s80, s80, s1
  s_xor_b32 s81, s81, s1
  s_xor_b32 s82, s82, s1
  s_xor_b32 s83, s83, s1
  s_xor_b32 s84, s84, s1
  s_xor_b32 s85, s85, s1
  s_xor_b32 s86, s86, s1
  s_xor_b32 s87, s87, s1
  s_xor_b32 s88, s88, s1
  s_xor_b32 s89, s89, s1
  s_xor_b32 s90, s90, s1
  s_xor_b32 s91, s91, s1
  s_or_b32 s76, s76, s84
  s_or_b32 s77, s77, s85
  s_or_b32 s78, s78, s86
  s_or_b32 s79, s79, s87
  s_or_b32 s80, s80, s88
  s_or_b32 s81, s81, s89
  s_or_b32 s82, s82, s90
  s_or_b32 s83, s83, s91
  s_or_b32 s76, s76, s80
  s_or_b32 s77, s77, s81
  s_or_b32 s78, s78, s82
  s_or_b32 s79, s79, s83
  s_or_b32 s76, s76, s78
  s_or_b32 s77, s77, s79
  s_or_b32 s76, s76, s77
  s_cmp_eq_u32 s76, 0
  s_cbranch_scc1 L_rp_18x
  s_sleep 2
  s_add_u32 s3, s3, 1
  s_cmp_gt_u32 s3, 20000
  s_cbranch_scc0 L_rp_18
L_rp_18x:
  v_mov_b32 v2, 157648
  v_mov_b32 v3, 1
  ds_write_b32 v2, v3
L_rp_18e:
  v_mov_b32 v2, 157648
  ds_read_b32 v239, v2
  s_waitcnt lgkmcnt(0)
  v_readfirstlane_b32 s43, v239
  s_nop 0
  s_cmp_lg_u32 s43, 0
  s_cbranch_scc1 L_rc_19x
  s_mov_b32 s3, 0
  v_mov_b32 v2, 157648
L_rc_19:
  ds_read_b32 v3, v2
  s_waitcnt lgkmcnt(0)
  v_readfirstlane_b32 s43, v3
  s_nop 0
  s_cmp_lg_u32 s43, 0
  s_cbranch_scc1 L_rc_19x
  s_sleep 1
  s_add_u32 s3, s3, 1
  s_cmp_gt_u32 s3, 160000
  s_cbranch_scc0 L_rc_19
L_rc_19x:
  buffer_load_dwordx4 v[144:147], v250, s[12:15], s46 offen offset:0 sc1
  buffer_load_dwordx4 v[148:151], v250, s[12:15], s47 offen offset:0 sc1
  buffer_load_dwordx4 v[152:155], v250, s[12:15], s46 offen offset:1024 sc1
  buffer_load_dwordx4 v[156:159], v250, s[12:15], s47 offen offset:1024 sc1
  buffer_load_dwordx4 v[160:163], v250, s[12:15], s48 offen offset:0 sc1
  buffer_load_dwordx4 v[164:167], v250, s[12:15], s49 offen offset:0 sc1
  s_waitcnt vmcnt(20)
  s_cmp_lg_u32 s36, 0
  s_cbranch_scc1 L_fa2_20
  s_mov_b32 s40, s55
  v_mov_b32 v2, 0
  v_mov_b32 v3, s1
  s_mov_b64 exec, 1
  buffer_store_dword v3, v2, s[12:15], s40 offen sc1
  s_mov_b64 exec, -1
L_fa2_20:
  s_waitcnt vmcnt(4)
  ds_read_b64_tr_b16 v[200:201], v252 offset:0
  ds_read_b64_tr_b16 v[202:203], v252 offset:1024
  ds_read_b64_tr_b16 v[204:205], v253 offset:0
  ds_read_b64_tr_b16 v[206:207], v253 offset:1024
  s_waitcnt lgkmcnt(0)
  v_mfma_f32_32x32x16_bf16 v[16:31], v[200:203], v[144:147], 0
  ds_read_b64_tr_b16 v[208:209], v252 offset:2048
  ds_read_b64_tr_b16 v[210:211], v252 offset:3072
  ds_read_b64_tr_b16 v[212:213], v253 offset:2048
  ds_read_b64_tr_b16 v[214:215], v253 offset:3072
  s_add_u32 m0, s67, 12288
  s_nop 0
  buffer_load_dwordx4 v251, s[16:19], s97 offen lds
  v_mfma_f32_32x32x16_bf16 v[32:47], v[204:207], v[144:147], 0
  buffer_load_dwordx4 v249, s[16:19], s97 offen offset:1024 lds
  v_mfma_f32_32x32x16_bf16 v[48:63], v[200:203], v[148:151], 0
  buffer_load_dwordx4 v[168:171], v250, s[12:15], s48 offen offset:1024 sc1
  v_mfma_f32_32x32x16_bf16 v[64:79], v[204:207], v[148:151], 0
  buffer_load_dwordx4 v[172:175], v250, s[12:15], s49 offen offset:1024 sc1
  s_waitcnt vmcnt(6) lgkmcnt(0)
  v_mfma_f32_32x32x16_bf16 v[16:31], v[208:211], v[152:155], v[16:31]
  ds_read_b64_tr_b16 v[200:201], v252 offset:4096
  ds_read_b64_tr_b16 v[202:203], v252 offset:5120
  ds_read_b64_tr_b16 v[204:205], v253 offset:4096
  ds_read_b64_tr_b16 v[206:207], v253 offset:5120
  s_add_u32 m0, s67, 0
  s_add_u32 s40, s97, 16384
  buffer_load_dwordx4 v251, s[16:19], s40 offen lds
  v_mfma_f32_32x32x16_bf16 v[32:47], v[212:215], v[152:155], v[32:47]
  buffer_load_dwordx4 v249, s[16:19], s40 offen offset:1024 lds
  v_mfma_f32_32x32x16_bf16 v[48:63], v[208:211], v[156:159], v[48:63]
  buffer_load_dwordx4 v[176:179], v250, s[12:15], s50 offen offset:0 sc1
  v_mfma_f32_32x32x16_bf16 v[64:79], v[212:215], v[156:159], v[64:79]
  buffer_load_dwordx4 v[180:183], v250, s[12:15], s51 offen offset:0 sc1
  s_waitcnt vmcnt(8) lgkmcnt(0)
  v_mfma_f32_32x32x16_bf16 v[16:31], v[200:203], v[160:163], v[16:31]
  ds_read_b64_tr_b16 v[208:209], v252 offset:6144
  ds_read_b64_tr_b16 v[210:211], v252 offset:7168
  ds_read_b64_tr_b16 v[212:213], v253 offset:6144
  ds_read_b64_tr_b16 v[214:215], v253 offset:7168
  s_cmp_lg_u32 s33, 1
  s_cbranch_scc1 L_rp_21e
  s_lshl_b32 s43, s62, 7
  s_add_u32 s43, s43, 20480
  s_add_u32 s94, s92, s43
  s_addc_u32 s95, s93, 0
  s_mov_b32 s3, 0
L_rp_21:
  s_load_dwordx16 s[76:91], s[94:95], 0 glc
  s_waitcnt lgkmcnt(0)
  s_xor_b32 s76, s76, s1
  s_xor_b32 s77, s77, s1
  s_xor_b32 s78, s78, s1
  s_xor_b32 s79, s79, s1
  s_xor_b32 s80, s80, s1
  s_xor_b32 s81, s81, s1
  s_xor_b32 s82, s82, s1
  s_xor_b32 s83, s83, s1
  s_xor_b32 s84, s84, s1
  s_xor_b32 s85, s85, s1
  s_xor_b32 s86, s86, s1
  s_xor_b32 s87, s87, s1
  s_xor_b32 s88, s88, s1
  s_xor_b32 s89, s89, s1
  s_xor_b32 s90, s90, s1
  s_xor_b32 s91, s91, s1
  s_or_b32 s76, s76, s84
  s_or_b32 s77, s77, s85
  s_or_b32 s78, s78, s86
  s_or_b32 s79, s79, s87
  s_or_b32 s80, s80, s88
  s_or_b32 s81, s81, s89
  s_or_b32 s82, s82, s90
  s_or_b32 s83, s83, s91
  s_or_b32 s76, s76, s80
  s_or_b32 s77, s77, s81
  s_or_b32 s78, s78, s82
  s_or_b32 s79, s79, s83
  s_or_b32 s76, s76, s78
  s_or_b32 s77, s77, s79
  s_or_b32 s76, s76, s77
  s_cmp_eq_u32 s76, 0
  s_cbranch_scc1 L_rp_21x
  s_sleep 2
  s_add_u32 s3, s3, 1
  s_cmp_gt_u32 s3, 20000
  s_cbranch_scc0 L_rp_21
L_rp_21x:
  v_mov_b32 v2, 157652
  v_mov_b32 v3, 1
  ds_write_b32 v2, v3
L_rp_21e:
  s_mov_b32 s58, 0
  s_and_b32 s43, s58, 1
  s_lshl_b32 s43, s43, 2
  s_and_b32 s58, s58, 2
  s_mul_i32 s58, s58, 10
  s_add_u32 s58, s58, s43
  s_xor_b32 s44, s0, 2
  s_add_u32 s58, s58, s44
  s_mov_b32 s59, 1
  s_and_b32 s43, s59, 1
  s_lshl_b32 s43, s43, 2
  s_and_b32 s59, s59, 2
  s_mul_i32 s59, s59, 10
  s_add_u32 s59, s59, s43
  s_xor_b32 s44, s0, 2
  s_add_u32 s59, s59, s44
  s_mov_b32 s60, 2
  s_and_b32 s43, s60, 1
  s_lshl_b32 s43, s43, 2
  s_and_b32 s60, s60, 2
  s_mul_i32 s60, s60, 10
  s_add_u32 s60, s60, s43
  s_xor_b32 s44, s0, 2
  s_add_u32 s60, s60, s44
  s_mov_b32 s61, 3
  s_and_b32 s43, s61, 1
  s_lshl_b32 s43, s43, 2
  s_and_b32 s61, s61, 2
  s_mul_i32 s61, s61, 10
  s_add_u32 s61, s61, s43
  s_xor_b32 s44, s0, 2
  s_add_u32 s61, s61, s44
  s_lshl_b32 s73, s58, 14
  s_add_u32 s73, s73, s66
  s_lshl_b32 s74, s59, 14
  s_add_u32 s74, s74, s66
  s_lshl_b32 s75, s60, 14
  s_add_u32 s75, s75, s66
  s_lshl_b32 s97, s61, 14
  s_add_u32 s97, s97, s66
  s_add_u32 m0, s67, 2048
  s_nop 0
  buffer_load_dwordx4 v251, s[16:19], s73 offen lds
  v_mfma_f32_32x32x16_bf16 v[32:47], v[204:207], v[160:163], v[32:47]
  buffer_load_dwordx4 v249, s[16:19], s73 offen offset:1024 lds
  v_mfma_f32_32x32x16_bf16 v[48:63], v[200:203], v[164:167], v[48:63]
  buffer_load_dwordx4 v[184:187], v250, s[12:15], s50 offen offset:1024 sc1
  v_mfma_f32_32x32x16_bf16 v[64:79], v[204:207], v[164:167], v[64:79]
  buffer_load_dwordx4 v[188:191], v250, s[12:15], s51 offen offset:1024 sc1
  s_waitcnt vmcnt(8) lgkmcnt(0)
  v_mfma_f32_32x32x16_bf16 v[16:31], v[208:211], v[168:171], v[16:31]
  ds_read_b64_tr_b16 v[200:201], v252 offset:8192
  ds_read_b64_tr_b16 v[202:203], v252 offset:9216
  ds_read_b64_tr_b16 v[204:205], v253 offset:8192
  ds_read_b64_tr_b16 v[206:207], v253 offset:9216
  v_mov_b32 v2, 157652
  ds_read_b32 v239, v2
  s_add_u32 m0, s67, 4096
  s_add_u32 s40, s73, 16384
  buffer_load_dwordx4 v251, s[16:19], s40 offen lds
  v_mfma_f32_32x32x16_bf16 v[32:47], v[212:215], v[168:171], v[32:47]
  buffer_load_dwordx4 v249, s[16:19], s40 offen offset:1024 lds
  v_mfma_f32_32x32x16_bf16 v[48:63], v[208:211], v[172:175], v[48:63]
  buffer_load_dwordx4 v[192:195], v250, s[12:15], s52 offen offset:0 sc1
  v_mfma_f32_32x32x16_bf16 v[64:79], v[212:215], v[172:175], v[64:79]
  buffer_load_dwordx4 v[196:199], v250, s[12:15], s53 offen offset:0 sc1
  s_waitcnt vmcnt(8) lgkmcnt(0)
  v_mfma_f32_32x32x16_bf16 v[16:31], v[200:203], v[176:179], v[16:31]
  ds_read_b64_tr_b16 v[208:209], v252 offset:10240
  ds_read_b64_tr_b16 v[210:211], v252 offset:11264
  ds_read_b64_tr_b16 v[212:213], v253 offset:10240
  ds_read_b64_tr_b16 v[214:215], v253 offset:11264
  v_readfirstlane_b32 s43, v239
  s_nop 0
  s_cmp_lg_u32 s43, 0
  s_cbranch_scc1 L_rc_22x
  s_mov_b32 s3, 0
  v_mov_b32 v2, 157652
L_rc_22:
  ds_read_b32 v3, v2
  s_waitcnt lgkmcnt(0)
  v_readfirstlane_b32 s43, v3
  s_nop 0
  s_cmp_lg_u32 s43, 0
  s_cbranch_scc1 L_rc_22x
  s_sleep 1
  s_add_u32 s3, s3, 1
  s_cmp_gt_u32 s3, 160000
  s_cbranch_scc0 L_rc_22
L_rc_22x:
  s_add_u32 m0, s67, 6144
  s_nop 0
  buffer_load_dwordx4 v251, s[16:19], s74 offen lds
  v_mfma_f32_32x32x16_bf16 v[32:47], v[204:207], v[176:179], v[32:47]
  buffer_load_dwordx4 v249, s[16:19], s74 offen offset:1024 lds
  v_mfma_f32_32x32x16_bf16 v[48:63], v[200:203], v[180:183], v[48:63]
  buffer_load_dwordx4 v[144:147], v250, s[12:15], s52 offen offset:1024 sc1
  v_mfma_f32_32x32x16_bf16 v[64:79], v[204:207], v[180:183], v[64:79]
  buffer_load_dwordx4 v[148:151], v250, s[12:15], s53 offen offset:1024 sc1
  s_waitcnt vmcnt(8) lgkmcnt(0)
  v_mfma_f32_32x32x16_bf16 v[16:31], v[208:211], v[184:187], v[16:31]
  ds_read_b64_tr_b16 v[200:201], v252 offset:12288
  ds_read_b64_tr_b16 v[202:203], v252 offset:13312
  ds_read_b64_tr_b16 v[204:205], v253 offset:12288
  ds_read_b64_tr_b16 v[206:207], v253 offset:13312
  s_add_u32 m0, s67, 8192
  s_add_u32 s40, s74, 16384
  buffer_load_dwordx4 v251, s[16:19], s40 offen lds
  v_mfma_f32_32x32x16_bf16 v[32:47], v[212:215], v[184:187], v[32:47]
  buffer_load_dwordx4 v249, s[16:19], s40 offen offset:1024 lds
  v_mfma_f32_32x32x16_bf16 v[48:63], v[208:211], v[188:191], v[48:63]
  s_lshl_b32 s43, s58, 10
  s_add_u32 s46, s43, s64
  s_add_u32 s47, s43, s65
  s_lshl_b32 s43, s59, 10
  s_add_u32 s48, s43, s64
  s_add_u32 s49, s43, s65
  s_lshl_b32 s43, s60, 10
  s_add_u32 s50, s43, s64
  s_add_u32 s51, s43, s65
  s_lshl_b32 s43, s61, 10
  s_add_u32 s52, s43, s64
  s_add_u32 s53, s43, s65
  buffer_load_dwordx4 v[152:155], v250, s[12:15], s46 offen offset:0 sc1
  v_mfma_f32_32x32x16_bf16 v[64:79], v[212:215], v[188:191], v[64:79]
  buffer_load_dwordx4 v[156:159], v250, s[12:15], s47 offen offset:0 sc1
  s_waitcnt vmcnt(8) lgkmcnt(0)
  v_mfma_f32_32x32x16_bf16 v[16:31], v[200:203], v[192:195], v[16:31]
  ds_read_b64_tr_b16 v[208:209], v252 offset:0
  ds_read_b64_tr_b16 v[210:211], v252 offset:1024
  ds_read_b64_tr_b16 v[212:213], v253 offset:0
  ds_read_b64_tr_b16 v[214:215], v253 offset:1024
  s_add_u32 m0, s67, 10240
  s_nop 0
  buffer_load_dwordx4 v251, s[16:19], s75 offen lds
  v_mfma_f32_32x32x16_bf16 v[32:47], v[204:207], v[192:195], v[32:47]
  buffer_load_dwordx4 v249, s[16:19], s75 offen offset:1024 lds
  v_mfma_f32_32x32x16_bf16 v[48:63], v[200:203], v[196:199], v[48:63]
  buffer_load_dwordx4 v[160:163], v250, s[12:15], s46 offen offset:1024 sc1
  v_mfma_f32_32x32x16_bf16 v[64:79], v[204:207], v[196:199], v[64:79]
  buffer_load_dwordx4 v[164:167], v250, s[12:15], s47 offen offset:1024 sc1
  s_waitcnt vmcnt(8) lgkmcnt(0)
  v_mfma_f32_32x32x16_bf16 v[16:31], v[208:211], v[144:147], v[16:31]
  ds_read_b64_tr_b16 v[200:201], v252 offset:2048
  ds_read_b64_tr_b16 v[202:203], v252 offset:3072
  ds_read_b64_tr_b16 v[204:205], v253 offset:2048
  ds_read_b64_tr_b16 v[206:207], v253 offset:3072
  s_add_u32 m0, s67, 12288
  s_add_u32 s40, s75, 16384
  buffer_load_dwordx4 v251, s[16:19], s40 offen lds
  v_mfma_f32_32x32x16_bf16 v[32:47], v[212:215], v[144:147], v[32:47]
  buffer_load_dwordx4 v249, s[16:19], s40 offen offset:1024 lds
  v_mfma_f32_32x32x16_bf16 v[48:63], v[208:211], v[148:151], v[48:63]
  buffer_load_dwordx4 v[168:171], v250, s[12:15], s48 offen offset:0 sc1
  v_mfma_f32_32x32x16_bf16 v[64:79], v[212:215], v[148:151], v[64:79]
  buffer_load_dwordx4 v[172:175], v250, s[12:15], s49 offen offset:0 sc1
  s_waitcnt vmcnt(8) lgkmcnt(0)
  v_mfma_f32_32x32x16_bf16 v[16:31], v[200:203], v[152:155], v[16:31]
  ds_read_b64_tr_b16 v[208:209], v252 offset:4096
  ds_read_b64_tr_b16 v[210:211], v252 offset:5120
  ds_read_b64_tr_b16 v[212:213], v253 offset:4096
  ds_read_b64_tr_b16 v[214:215], v253 offset:5120
  s_add_u32 m0, s67, 0
  s_nop 0
  buffer_load_dwordx4 v251, s[16:19], s97 offen lds
  v_mfma_f32_32x32x16_bf16 v[32:47], v[204:207], v[152:155], v[32:47]
  buffer_load_dwordx4 v249, s[16:19], s97 offen offset:1024 lds
  v_mfma_f32_32x32x16_bf16 v[48:63], v[200:203], v[156:159], v[48:63]
  buffer_load_dwordx4 v[176:179], v250, s[12:15], s48 offen offset:1024 sc1
  v_mfma_f32_32x32x16_bf16 v[64:79], v[204:207], v[156:159], v[64:79]
  buffer_load_dwordx4 v[180:183], v250, s[12:15], s49 offen offset:1024 sc1
  s_waitcnt vmcnt(8) lgkmcnt(0)
  v_mfma_f32_32x32x16_bf16 v[16:31], v[208:211], v[160:163], v[16:31]
  ds_read_b64_tr_b16 v[200:201], v252 offset:6144
  ds_read_b64_tr_b16 v[202:203], v252 offset:7168
  ds_read_b64_tr_b16 v[204:205], v253 offset:6144
  ds_read_b64_tr_b16 v[206:207], v253 offset:7168
  s_add_u32 m0, s67, 2048
  s_add_u32 s40, s97, 16384
  buffer_load_dwordx4 v251, s[16:19], s40 offen lds
  v_mfma_f32_32x32x16_bf16 v[32:47], v[212:215], v[160:163], v[32:47]
  buffer_load_dwordx4 v249, s[16:19], s40 offen offset:1024 lds
  v_mfma_f32_32x32x16_bf16 v[48:63], v[208:211], v[164:167], v[48:63]
  buffer_load_dwordx4 v[184:187], v250, s[12:15], s50 offen offset:0 sc1
  v_mfma_f32_32x32x16_bf16 v[64:79], v[212:215], v[164:167], v[64:79]
  buffer_load_dwordx4 v[188:191], v250, s[12:15], s51 offen offset:0 sc1
  s_waitcnt vmcnt(8) lgkmcnt(0)
  v_mfma_f32_32x32x16_bf16 v[16:31], v[200:203], v[168:171], v[16:31]
  ds_read_b64_tr_b16 v[208:209], v252 offset:8192
  ds_read_b64_tr_b16 v[210:211], v252 offset:9216
  ds_read_b64_tr_b16 v[212:213], v253 offset:8192
  ds_read_b64_tr_b16 v[214:215], v253 offset:9216
  s_cmp_lg_u32 s33, 2
  s_cbranch_scc1 L_rp_23e
  s_lshl_b32 s43, s62, 7
  s_add_u32 s43, s43, 4096
  s_add_u32 s94, s92, s43
  s_addc_u32 s95, s93, 0
  s_mov_b32 s3, 0
L_rp_23:
  s_load_dwordx16 s[76:91], s[94:95], 0 glc
  s_waitcnt lgkmcnt(0)
  s_xor_b32 s76, s76, s1
  s_xor_b32 s77, s77, s1
  s_xor_b32 s78, s78, s1
  s_xor_b32 s79, s79, s1
  s_xor_b32 s80, s80, s1
  s_xor_b32 s81, s81, s1
  s_xor_b32 s82, s82, s1
  s_xor_b32 s83, s83, s1
  s_xor_b32 s84, s84, s1
  s_xor_b32 s85, s85, s1
  s_xor_b32 s86, s86, s1
  s_xor_b32 s87, s87, s1
  s_xor_b32 s88, s88, s1
  s_xor_b32 s89, s89, s1
  s_xor_b32 s90, s90, s1
  s_xor_b32 s91, s91, s1
  s_or_b32 s76, s76, s84
  s_or_b32 s77, s77, s85
  s_or_b32 s78, s78, s86
  s_or_b32 s79, s79, s87
  s_or_b32 s80, s80, s88
  s_or_b32 s81, s81, s89
  s_or_b32 s82, s82, s90
  s_or_b32 s83, s83, s91
  s_or_b32 s76, s76, s80
  s_or_b32 s77, s77, s81
  s_or_b32 s78, s78, s82
  s_or_b32 s79, s79, s83
  s_or_b32 s76, s76, s78
  s_or_b32 s77, s77, s79
  s_or_b32 s76, s76, s77
  s_cmp_eq_u32 s76, 0
  s_cbranch_scc1 L_rp_23x
  s_sleep 2
  s_add_u32 s3, s3, 1
  s_cmp_gt_u32 s3, 20000
  s_cbranch_scc0 L_rp_23
L_rp_23x:
  v_mov_b32 v2, 157656
  v_mov_b32 v3, 1
  ds_write_b32 v2, v3
L_rp_23e:
  s_mov_b32 s58, 0
  s_mul_i32 s58, s58, 3
  s_add_u32 s58, s58, 8
  s_mov_b32 s59, 1
  s_mul_i32 s59, s59, 3
  s_add_u32 s59, s59, 8
  s_mov_b32 s60, 2
  s_mul_i32 s60, s60, 3
  s_add_u32 s60, s60, 8
  s_mov_b32 s61, 3
  s_mul_i32 s61, s61, 3
  s_add_u32 s61, s61, 8
  s_lshl_b32 s73, s58, 14
  s_add_u32 s73, s73, s66
  s_lshl_b32 s74, s59, 14
  s_add_u32 s74, s74, s66
  s_lshl_b32 s75, s60, 14
  s_add_u32 s75, s75, s66
  s_lshl_b32 s97, s61, 14
  s_add_u32 s97, s97, s66
  s_add_u32 m0, s67, 4096
  s_nop 0
  buffer_load_dwordx4 v251, s[16:19], s73 offen lds
  v_mfma_f32_32x32x16_bf16 v[32:47], v[204:207], v[168:171], v[32:47]
  buffer_load_dwordx4 v249, s[16:19], s73 offen offset:1024 lds
  v_mfma_f32_32x32x16_bf16 v[48:63], v[200:203], v[172:175], v[48:63]
  buffer_load_dwordx4 v[192:195], v250, s[12:15], s50 offen offset:1024 sc1
  v_mfma_f32_32x32x16_bf16 v[64:79], v[204:207], v[172:175], v[64:79]
  buffer_load_dwordx4 v[196:199], v250, s[12:15], s51 offen offset:1024 sc1
  s_waitcnt vmcnt(8) lgkmcnt(0)
  v_mfma_f32_32x32x16_bf16 v[16:31], v[208:211], v[176:179], v[16:31]
  ds_read_b64_tr_b16 v[200:201], v252 offset:10240
  ds_read_b64_tr_b16 v[202:203], v252 offset:11264
  ds_read_b64_tr_b16 v[204:205], v253 offset:10240
  ds_read_b64_tr_b16 v[206:207], v253 offset:11264
  v_mov_b32 v2, 157656
  ds_read_b32 v239, v2
  v_mov_b32 v2, 157688
  s_mov_b32 s3, 0
L_cw_24:
  ds_read_b32 v3, v2
  s_waitcnt lgkmcnt(0)
  v_readfirstlane_b32 s43, v3
  s_nop 0
  s_cmp_ge_u32 s43, 4
  s_cbranch_scc1 L_cw_24x
  s_sleep 1
  s_add_u32 s3, s3, 1
  s_cmp_gt_u32 s3, 160000
  s_cbranch_scc0 L_cw_24
L_cw_24x:
  s_add_u32 m0, s96, 0
  s_add_u32 s40, s73, 16384
  buffer_load_dwordx4 v251, s[16:19], s40 offen lds
  v_mfma_f32_32x32x16_bf16 v[32:47], v[212:215], v[176:179], v[32:47]
  buffer_load_dwordx4 v249, s[16:19], s40 offen offset:1024 lds
  v_mfma_f32_32x32x16_bf16 v[48:63], v[208:211], v[180:183], v[48:63]
  s_add_u32 m0, s96, 2048
  s_add_u32 s40, s73, 32768
  buffer_load_dwordx4 v251, s[16:19], s40 offen lds
  v_mfma_f32_32x32x16_bf16 v[64:79], v[212:215], v[180:183], v[64:79]
  buffer_load_dwordx4 v249, s[16:19], s40 offen offset:1024 lds
  s_add_u32 m0, s96, 4096
  s_nop 0
  buffer_load_dwordx4 v251, s[16:19], s74 offen lds
  buffer_load_dwordx4 v249, s[16:19], s74 offen offset:1024 lds
  s_add_u32 m0, s96, 6144
  s_add_u32 s40, s74, 16384
  buffer_load_dwordx4 v251, s[16:19], s40 offen lds
  buffer_load_dwordx4 v249, s[16:19], s40 offen offset:1024 lds
  buffer_load_dwordx4 v[144:147], v250, s[12:15], s52 offen offset:0 sc1
  buffer_load_dwordx4 v[148:151], v250, s[12:15], s53 offen offset:0 sc1
  s_waitcnt vmcnt(14) lgkmcnt(0)
  v_mfma_f32_32x32x16_bf16 v[16:31], v[200:203], v[184:187], v[16:31]
  ds_read_b64_tr_b16 v[208:209], v252 offset:12288
  ds_read_b64_tr_b16 v[210:211], v252 offset:13312
  ds_read_b64_tr_b16 v[212:213], v253 offset:12288
  ds_read_b64_tr_b16 v[214:215], v253 offset:13312
  v_readfirstlane_b32 s43, v239
  s_nop 0
  s_cmp_lg_u32 s43, 0
  s_cbranch_scc1 L_rc_25x
  s_mov_b32 s3, 0
  v_mov_b32 v2, 157656
L_rc_25:
  ds_read_b32 v3, v2
  s_waitcnt lgkmcnt(0)
  v_readfirstlane_b32 s43, v3
  s_nop 0
  s_cmp_lg_u32 s43, 0
  s_cbranch_scc1 L_rc_25x
  s_sleep 1
  s_add_u32 s3, s3, 1
  s_cmp_gt_u32 s3, 160000
  s_cbranch_scc0 L_rc_25
L_rc_25x:
  buffer_load_dwordx4 v[152:155], v250, s[12:15], s52 offen offset:1024 sc1
  v_mfma_f32_32x32x16_bf16 v[32:47], v[204:207], v[184:187], v[32:47]
  buffer_load_dwordx4 v[156:159], v250, s[12:15], s53 offen offset:1024 sc1
  v_mfma_f32_32x32x16_bf16 v[48:63], v[200:203], v[188:191], v[48:63]
  v_mfma_f32_32x32x16_bf16 v[64:79], v[204:207], v[188:191], v[64:79]
  s_waitcnt vmcnt(12) lgkmcnt(0)
  v_mfma_f32_32x32x16_bf16 v[16:31], v[208:211], v[192:195], v[16:31]
  ds_read_b64_tr_b16 v[200:201], v252 offset:0
  ds_read_b64_tr_b16 v[202:203], v252 offset:1024
  ds_read_b64_tr_b16 v[204:205], v253 offset:0
  ds_read_b64_tr_b16 v[206:207], v253 offset:1024
  s_lshl_b32 s43, s58, 10
  s_add_u32 s46, s43, s64
  s_add_u32 s47, s43, s65
  s_lshl_b32 s43, s59, 10
  s_add_u32 s48, s43, s64
  s_add_u32 s49, s43, s65
  s_lshl_b32 s43, s60, 10
  s_add_u32 s50, s43, s64
  s_add_u32 s51, s43, s65
  s_lshl_b32 s43, s61, 10
  s_add_u32 s52, s43, s64
  s_add_u32 s53, s43, s65
  buffer_load_dwordx4 v[160:163], v250, s[12:15], s46 offen offset:0 sc1
  v_mfma_f32_32x32x16_bf16 v[32:47], v[212:215], v[192:195], v[32:47]
  buffer_load_dwordx4 v[164:167], v250, s[12:15], s47 offen offset:0 sc1
  v_mfma_f32_32x32x16_bf16 v[48:63], v[208:211], v[196:199], v[48:63]
  v_mfma_f32_32x32x16_bf16 v[64:79], v[212:215], v[196:199], v[64:79]
  s_waitcnt vmcnt(4) lgkmcnt(0)
  v_mfma_f32_32x32x16_bf16 v[16:31], v[200:203], v[144:147], v[16:31]
  ds_read_b64_tr_b16 v[208:209], v252 offset:2048
  ds_read_b64_tr_b16 v[210:211], v252 offset:3072
  ds_read_b64_tr_b16 v[212:213], v253 offset:2048
  ds_read_b64_tr_b16 v[214:215], v253 offset:3072
  buffer_load_dwordx4 v[168:171], v250, s[12:15], s46 offen offset:1024 sc1
  v_mfma_f32_32x32x16_bf16 v[32:47], v[204:207], v[144:147], v[32:47]
  buffer_load_dwordx4 v[172:175], v250, s[12:15], s47 offen offset:1024 sc1
  v_mfma_f32_32x32x16_bf16 v[48:63], v[200:203], v[148:151], v[48:63]
  v_mfma_f32_32x32x16_bf16 v[64:79], v[204:207], v[148:151], v[64:79]
  s_waitcnt vmcnt(4) lgkmcnt(0)
  v_mfma_f32_32x32x16_bf16 v[16:31], v[208:211], v[152:155], v[16:31]
  ds_read_b64_tr_b16 v[200:201], v252 offset:4096
  ds_read_b64_tr_b16 v[202:203], v252 offset:5120
  ds_read_b64_tr_b16 v[204:205], v253 offset:4096
  ds_read_b64_tr_b16 v[206:207], v253 offset:5120
  s_add_u32 m0, s67, 6144
  s_add_u32 s40, s74, 32768
  buffer_load_dwordx4 v251, s[16:19], s40 offen lds
  v_mfma_f32_32x32x16_bf16 v[32:47], v[212:215], v[152:155], v[32:47]
  buffer_load_dwordx4 v249, s[16:19], s40 offen offset:1024 lds
  v_mfma_f32_32x32x16_bf16 v[48:63], v[208:211], v[156:159], v[48:63]
  buffer_load_dwordx4 v[176:179], v250, s[12:15], s46 offen offset:2048 sc1
  v_mfma_f32_32x32x16_bf16 v[64:79], v[212:215], v[156:159], v[64:79]
  buffer_load_dwordx4 v[180:183], v250, s[12:15], s47 offen offset:2048 sc1
  s_waitcnt vmcnt(6) lgkmcnt(0)
  v_mfma_f32_32x32x16_bf16 v[16:31], v[200:203], v[160:163], v[16:31]
  ds_read_b64_tr_b16 v[208:209], v236 offset:0
  ds_read_b64_tr_b16 v[210:211], v236 offset:1024
  ds_read_b64_tr_b16 v[212:213], v237 offset:0
  ds_read_b64_tr_b16 v[214:215], v237 offset:1024
  s_add_u32 m0, s67, 8192
  s_nop 0
  buffer_load_dwordx4 v251, s[16:19], s75 offen lds
  v_mfma_f32_32x32x16_bf16 v[32:47], v[204:207], v[160:163], v[32:47]
  buffer_load_dwordx4 v249, s[16:19], s75 offen offset:1024 lds
  v_mfma_f32_32x32x16_bf16 v[48:63], v[200:203], v[164:167], v[48:63]
  buffer_load_dwordx4 v[184:187], v250, s[12:15], s48 offen offset:0 sc1
  v_mfma_f32_32x32x16_bf16 v[64:79], v[204:207], v[164:167], v[64:79]
  buffer_load_dwordx4 v[188:191], v250, s[12:15], s49 offen offset:0 sc1
  s_waitcnt vmcnt(8) lgkmcnt(0)
  v_mfma_f32_32x32x16_bf16 v[16:31], v[208:211], v[168:171], v[16:31]
  ds_read_b64_tr_b16 v[200:201], v236 offset:2048
  ds_read_b64_tr_b16 v[202:203], v236 offset:3072
  ds_read_b64_tr_b16 v[204:205], v237 offset:2048
  ds_read_b64_tr_b16 v[206:207], v237 offset:3072
  s_add_u32 m0, s67, 10240
  s_add_u32 s40, s75, 16384
  buffer_load_dwordx4 v251, s[16:19], s40 offen lds
  v_mfma_f32_32x32x16_bf16 v[32:47], v[212:215], v[168:171], v[32:47]
  buffer_load_dwordx4 v249, s[16:19], s40 offen offset:1024 lds
  v_mfma_f32_32x32x16_bf16 v[48:63], v[208:211], v[172:175], v[48:63]
  buffer_load_dwordx4 v[192:195], v250, s[12:15], s48 offen offset:1024 sc1
  v_mfma_f32_32x32x16_bf16 v[64:79], v[212:215], v[172:175], v[64:79]
  buffer_load_dwordx4 v[196:199], v250, s[12:15], s49 offen offset:1024 sc1
  s_waitcnt vmcnt(8) lgkmcnt(0)
  v_mfma_f32_32x32x16_bf16 v[16:31], v[200:203], v[176:179], v[16:31]
  ds_read_b64_tr_b16 v[208:209], v236 offset:4096
  ds_read_b64_tr_b16 v[210:211], v236 offset:5120
  ds_read_b64_tr_b16 v[212:213], v237 offset:4096
  ds_read_b64_tr_b16 v[214:215], v237 offset:5120
  s_add_u32 m0, s67, 12288
  s_add_u32 s40, s75, 32768
  buffer_load_dwordx4 v251, s[16:19], s40 offen lds
  v_mfma_f32_32x32x16_bf16 v[32:47], v[204:207], v[176:179], v[32:47]
  buffer_load_dwordx4 v249, s[16:19], s40 offen offset:1024 lds
  v_mfma_f32_32x32x16_bf16 v[48:63], v[200:203], v[180:183], v[48:63]
  buffer_load_dwordx4 v[144:147], v250, s[12:15], s48 offen offset:2048 sc1
  v_mfma_f32_32x32x16_bf16 v[64:79], v[204:207], v[180:183], v[64:79]
  buffer_load_dwordx4 v[148:151], v250, s[12:15], s49 offen offset:2048 sc1
  s_waitcnt vmcnt(8) lgkmcnt(0)
  v_mfma_f32_32x32x16_bf16 v[16:31], v[208:211], v[184:187], v[16:31]
  ds_read_b64_tr_b16 v[200:201], v236 offset:6144
  ds_read_b64_tr_b16 v[202:203], v236 offset:7168
  ds_read_b64_tr_b16 v[204:205], v237 offset:6144
  ds_read_b64_tr_b16 v[206:207], v237 offset:7168
  s_add_u32 m0, s67, 0
  s_nop 0
  buffer_load_dwordx4 v251, s[16:19], s97 offen lds
  v_mfma_f32_32x32x16_bf16 v[32:47], v[212:215], v[184:187], v[32:47]
  buffer_load_dwordx4 v249, s[16:19], s97 offen offset:1024 lds
  v_mfma_f32_32x32x16_bf16 v[48:63], v[208:211], v[188:191], v[48:63]
  buffer_load_dwordx4 v[152:155], v250, s[12:15], s50 offen offset:0 sc1
  v_mfma_f32_32x32x16_bf16 v[64:79], v[212:215], v[188:191], v[64:79]
  buffer_load_dwordx4 v[156:159], v250, s[12:15], s51 offen offset:0 sc1
  s_waitcnt vmcnt(8) lgkmcnt(0)
  v_mfma_f32_32x32x16_bf16 v[16:31], v[200:203], v[192:195], v[16:31]
  ds_read_b64_tr_b16 v[208:209], v252 offset:6144
  ds_read_b64_tr_b16 v[210:211], v252 offset:7168
  ds_read_b64_tr_b16 v[212:213], v253 offset:6144
  ds_read_b64_tr_b16 v[214:215], v253 offset:7168
  s_add_u32 m0, s67, 2048
  s_add_u32 s40, s97, 16384
  buffer_load_dwordx4 v251, s[16:19], s40 offen lds
  v_mfma_f32_32x32x16_bf16 v[32:47], v[204:207], v[192:195], v[32:47]
  buffer_load_dwordx4 v249, s[16:19], s40 offen offset:1024 lds
  v_mfma_f32_32x32x16_bf16 v[48:63], v[200:203], v[196:199], v[48:63]
  buffer_load_dwordx4 v[160:163], v250, s[12:15], s50 offen offset:1024 sc1
  v_mfma_f32_32x32x16_bf16 v[64:79], v[204:207], v[196:199], v[64:79]
  buffer_load_dwordx4 v[164:167], v250, s[12:15], s51 offen offset:1024 sc1
  s_waitcnt vmcnt(8) lgkmcnt(0)
  v_mfma_f32_32x32x16_bf16 v[16:31], v[208:211], v[144:147], v[16:31]
  ds_read_b64_tr_b16 v[200:201], v252 offset:8192
  ds_read_b64_tr_b16 v[202:203], v252 offset:9216
  ds_read_b64_tr_b16 v[204:205], v253 offset:8192
  ds_read_b64_tr_b16 v[206:207], v253 offset:9216
  s_add_u32 m0, s67, 4096
  s_add_u32 s40, s97, 32768
  buffer_load_dwordx4 v251, s[16:19], s40 offen lds
  v_mfma_f32_32x32x16_bf16 v[32:47], v[212:215], v[144:147], v[32:47]
  buffer_load_dwordx4 v249, s[16:19], s40 offen offset:1024 lds
  v_mfma_f32_32x32x16_bf16 v[48:63], v[208:211], v[148:151], v[48:63]
  buffer_load_dwordx4 v[168:171], v250, s[12:15], s50 offen offset:2048 sc1
  v_mfma_f32_32x32x16_bf16 v[64:79], v[212:215], v[148:151], v[64:79]
  buffer_load_dwordx4 v[172:175], v250, s[12:15], s51 offen offset:2048 sc1
  s_waitcnt vmcnt(8) lgkmcnt(0)
  v_mfma_f32_32x32x16_bf16 v[16:31], v[200:203], v[152:155], v[16:31]
  ds_read_b64_tr_b16 v[208:209], v252 offset:10240
  ds_read_b64_tr_b16 v[210:211], v252 offset:11264
  ds_read_b64_tr_b16 v[212:213], v253 offset:10240
  ds_read_b64_tr_b16 v[214:215], v253 offset:11264
  s_cmp_lg_u32 s33, 3
  s_cbranch_scc1 L_rp_26e
  s_lshl_b32 s43, s62, 7
  s_add_u32 s43, s43, 8192
  s_add_u32 s94, s92, s43
  s_addc_u32 s95, s93, 0
  s_mov_b32 s3, 0
L_rp_26:
  s_load_dwordx16 s[76:91], s[94:95], 0 glc
  s_waitcnt lgkmcnt(0)
  s_xor_b32 s76, s76, s1
  s_xor_b32 s77, s77, s1
  s_xor_b32 s78, s78, s1
  s_xor_b32 s79, s79, s1
  s_xor_b32 s80, s80, s1
  s_xor_b32 s81, s81, s1
  s_xor_b32 s82, s82, s1
  s_xor_b32 s83, s83, s1
  s_xor_b32 s84, s84, s1
  s_xor_b32 s85, s85, s1
  s_xor_b32 s86, s86, s1
  s_xor_b32 s87, s87, s1
  s_xor_b32 s88, s88, s1
  s_xor_b32 s89, s89, s1
  s_xor_b32 s90, s90, s1
  s_xor_b32 s91, s91, s1
  s_or_b32 s76, s76, s84
  s_or_b32 s77, s77, s85
  s_or_b32 s78, s78, s86
  s_or_b32 s79, s79, s87
  s_or_b32 s80, s80, s88
  s_or_b32 s81, s81, s89
  s_or_b32 s82, s82, s90
  s_or_b32 s83, s83, s91
  s_or_b32 s76, s76, s80
  s_or_b32 s77, s77, s81
  s_or_b32 s78, s78, s82
  s_or_b32 s79, s79, s83
  s_or_b32 s76, s76, s78
  s_or_b32 s77, s77, s79
  s_or_b32 s76, s76, s77
  s_cmp_eq_u32 s76, 0
  s_cbranch_scc1 L_rp_26x
  s_sleep 2
  s_add_u32 s3, s3, 1
  s_cmp_gt_u32 s3, 20000
  s_cbranch_scc0 L_rp_26
L_rp_26x:
  v_mov_b32 v2, 157660
  v_mov_b32 v3, 1
  ds_write_b32 v2, v3
L_rp_26e:
  s_mov_b32 s58, 0
  s_lshl_b32 s58, s58, 1
  s_mov_b32 s59, 1
  s_lshl_b32 s59, s59, 1
  s_mov_b32 s60, 2
  s_lshl_b32 s60, s60, 1
  s_mov_b32 s61, 3
  s_lshl_b32 s61, s61, 1
  s_lshl_b32 s73, s58, 14
  s_add_u32 s73, s73, s39
  s_lshl_b32 s74, s59, 14
  s_add_u32 s74, s74, s39
  s_lshl_b32 s75, s60, 14
  s_add_u32 s75, s75, s39
  s_lshl_b32 s97, s61, 14
  s_add_u32 s97, s97, s39
  s_add_u32 m0, s67, 6144
  s_nop 0
  buffer_load_dwordx4 v251, s[20:23], s73 offen lds
  v_mfma_f32_32x32x16_bf16 v[32:47], v[204:207], v[152:155], v[32:47]
  buffer_load_dwordx4 v249, s[20:23], s73 offen offset:1024 lds
  v_mfma_f32_32x32x16_bf16 v[48:63], v[200:203], v[156:159], v[48:63]
  buffer_load_dwordx4 v[176:179], v250, s[12:15], s52 offen offset:0 sc1
  v_mfma_f32_32x32x16_bf16 v[64:79], v[204:207], v[156:159], v[64:79]
  buffer_load_dwordx4 v[180:183], v250, s[12:15], s53 offen offset:0 sc1
  s_waitcnt vmcnt(8) lgkmcnt(0)
  v_mfma_f32_32x32x16_bf16 v[16:31], v[208:211], v[160:163], v[16:31]
  ds_read_b64_tr_b16 v[200:201], v252 offset:12288
  ds_read_b64_tr_b16 v[202:203], v252 offset:13312
  ds_read_b64_tr_b16 v[204:205], v253 offset:12288
  ds_read_b64_tr_b16 v[206:207], v253 offset:13312
  v_mov_b32 v2, 157660
  ds_read_b32 v239, v2
  s_add_u32 m0, s67, 8192
  s_add_u32 s40, s73, 16384
  buffer_load_dwordx4 v251, s[20:23], s40 offen lds
  v_mfma_f32_32x32x16_bf16 v[32:47], v[212:215], v[160:163], v[32:47]
  buffer_load_dwordx4 v249, s[20:23], s40 offen offset:1024 lds
  v_mfma_f32_32x32x16_bf16 v[48:63], v[208:211], v[164:167], v[48:63]
  buffer_load_dwordx4 v[184:187], v250, s[12:15], s52 offen offset:1024 sc1
  v_mfma_f32_32x32x16_bf16 v[64:79], v[212:215], v[164:167], v[64:79]
  buffer_load_dwordx4 v[188:191], v250, s[12:15], s53 offen offset:1024 sc1
  s_waitcnt vmcnt(8) lgkmcnt(0)
  v_mfma_f32_32x32x16_bf16 v[16:31], v[200:203], v[168:171], v[16:31]
  ds_read_b64_tr_b16 v[208:209], v252 offset:0
  ds_read_b64_tr_b16 v[210:211], v252 offset:1024
  ds_read_b64_tr_b16 v[212:213], v253 offset:0
  ds_read_b64_tr_b16 v[214:215], v253 offset:1024
  v_readfirstlane_b32 s43, v239
  s_nop 0
  s_cmp_lg_u32 s43, 0
  s_cbranch_scc1 L_rc_27x
  s_mov_b32 s3, 0
  v_mov_b32 v2, 157660
L_rc_27:
  ds_read_b32 v3, v2
  s_waitcnt lgkmcnt(0)
  v_readfirstlane_b32 s43, v3
  s_nop 0
  s_cmp_lg_u32 s43, 0
  s_cbranch_scc1 L_rc_27x
  s_sleep 1
  s_add_u32 s3, s3, 1
  s_cmp_gt_u32 s3, 160000
  s_cbranch_scc0 L_rc_27
L_rc_27x:
  s_add_u32 m0, s67, 10240
  s_nop 0
  buffer_load_dwordx4 v251, s[20:23], s74 offen lds
  v_mfma_f32_32x32x16_bf16 v[32:47], v[204:207], v[168:171], v[32:47]
  buffer_load_dwordx4 v249, s[20:23], s74 offen offset:1024 lds
  v_mfma_f32_32x32x16_bf16 v[48:63], v[200:203], v[172:175], v[48:63]
  buffer_load_dwordx4 v[192:195], v250, s[12:15], s52 offen offset:2048 sc1
  v_mfma_f32_32x32x16_bf16 v[64:79], v[204:207], v[172:175], v[64:79]
  buffer_load_dwordx4 v[196:199], v250, s[12:15], s53 offen offset:2048 sc1
  s_waitcnt vmcnt(8) lgkmcnt(0)
  v_mfma_f32_32x32x16_bf16 v[16:31], v[208:211], v[176:179], v[16:31]
  ds_read_b64_tr_b16 v[200:201], v252 offset:2048
  ds_read_b64_tr_b16 v[202:203], v252 offset:3072
  ds_read_b64_tr_b16 v[204:205], v253 offset:2048
  ds_read_b64_tr_b16 v[206:207], v253 offset:3072
  s_add_u32 m0, s67, 12288
  s_add_u32 s40, s74, 16384
  buffer_load_dwordx4 v251, s[20:23], s40 offen lds
  v_mfma_f32_32x32x16_bf16 v[32:47], v[212:215], v[176:179], v[32:47]
  buffer_load_dwordx4 v249, s[20:23], s40 offen offset:1024 lds
  v_mfma_f32_32x32x16_bf16 v[48:63], v[208:211], v[180:183], v[48:63]
  s_lshl_b32 s43, s58, 10
  s_add_u32 s46, s43, s68
  s_add_u32 s47, s43, s69
  s_lshl_b32 s43, s59, 10
  s_add_u32 s48, s43, s68
  s_add_u32 s49, s43, s69
  s_lshl_b32 s43, s60, 10
  s_add_u32 s50, s43, s68
  s_add_u32 s51, s43, s69
  s_lshl_b32 s43, s61, 10
  s_add_u32 s52, s43, s68
  s_add_u32 s53, s43, s69
  buffer_load_dwordx4 v[144:147], v250, s[12:15], s46 offen offset:0 sc1
  v_mfma_f32_32x32x16_bf16 v[64:79], v[212:215], v[180:183], v[64:79]
  buffer_load_dwordx4 v[148:151], v250, s[12:15], s47 offen offset:0 sc1
  s_waitcnt vmcnt(8) lgkmcnt(0)
  v_mfma_f32_32x32x16_bf16 v[16:31], v[200:203], v[184:187], v[16:31]
  ds_read_b64_tr_b16 v[208:209], v252 offset:4096
  ds_read_b64_tr_b16 v[210:211], v252 offset:5120
  ds_read_b64_tr_b16 v[212:213], v253 offset:4096
  ds_read_b64_tr_b16 v[214:215], v253 offset:5120
  s_add_u32 m0, s67, 0
  s_nop 0
  buffer_load_dwordx4 v251, s[20:23], s75 offen lds
  v_mfma_f32_32x32x16_bf16 v[32:47], v[204:207], v[184:187], v[32:47]
  buffer_load_dwordx4 v249, s[20:23], s75 offen offset:1024 lds
  v_mfma_f32_32x32x16_bf16 v[48:63], v[200:203], v[188:191], v[48:63]
  buffer_load_dwordx4 v[152:155], v250, s[12:15], s46 offen offset:1024 sc1
  v_mfma_f32_32x32x16_bf16 v[64:79], v[204:207], v[188:191], v[64:79]
  buffer_load_dwordx4 v[156:159], v250, s[12:15], s47 offen offset:1024 sc1
  s_waitcnt vmcnt(8) lgkmcnt(0)
  v_mfma_f32_32x32x16_bf16 v[16:31], v[208:211], v[192:195], v[16:31]
  ds_read_b64_tr_b16 v[200:201], v252 offset:6144
  ds_read_b64_tr_b16 v[202:203], v252 offset:7168
  ds_read_b64_tr_b16 v[204:205], v253 offset:6144
  ds_read_b64_tr_b16 v[206:207], v253 offset:7168
  s_add_u32 m0, s67, 2048
  s_add_u32 s40, s75, 16384
  buffer_load_dwordx4 v251, s[20:23], s40 offen lds
  v_mfma_f32_32x32x16_bf16 v[32:47], v[212:215], v[192:195], v[32:47]
  buffer_load_dwordx4 v249, s[20:23], s40 offen offset:1024 lds
  v_mfma_f32_32x32x16_bf16 v[48:63], v[208:211], v[196:199], v[48:63]
  buffer_load_dwordx4 v[160:163], v250, s[12:15], s48 offen offset:0 sc1
  v_mfma_f32_32x32x16_bf16 v[64:79], v[212:215], v[196:199], v[64:79]
  buffer_load_dwordx4 v[164:167], v250, s[12:15], s49 offen offset:0 sc1
  s_waitcnt vmcnt(8) lgkmcnt(0)
  v_mfma_f32_32x32x16_bf16 v[80:95], v[200:203], v[144:147], 0
  ds_read_b64_tr_b16 v[208:209], v252 offset:8192
  ds_read_b64_tr_b16 v[210:211], v252 offset:9216
  ds_read_b64_tr_b16 v[212:213], v253 offset:8192
  ds_read_b64_tr_b16 v[214:215], v253 offset:9216
  s_add_u32 m0, s67, 4096
  s_nop 0
  buffer_load_dwordx4 v251, s[20:23], s97 offen lds
  v_mfma_f32_32x32x16_bf16 v[96:111], v[204:207], v[144:147], 0
  buffer_load_dwordx4 v249, s[20:23], s97 offen offset:1024 lds
  v_mfma_f32_32x32x16_bf16 v[112:127], v[200:203], v[148:151], 0
  buffer_load_dwordx4 v[168:171], v250, s[12:15], s48 offen offset:1024 sc1
  v_mfma_f32_32x32x16_bf16 v[128:143], v[204:207], v[148:151], 0
  buffer_load_dwordx4 v[172:175], v250, s[12:15], s49 offen offset:1024 sc1
  v_mov_b32 v2, 157688
  s_mov_b32 s3, 0
L_cw_28:
  ds_read_b32 v3, v2
  s_waitcnt lgkmcnt(0)
  v_readfirstlane_b32 s43, v3
  s_nop 0
  s_cmp_ge_u32 s43, 4
  s_cbranch_scc1 L_cw_28x
  s_sleep 1
  s_add_u32 s3, s3, 1
  s_cmp_gt_u32 s3, 160000
  s_cbranch_scc0 L_cw_28
L_cw_28x:
  s_xor_b32 s40, s33, 1
  s_mul_i32 s40, s40, 12288
  s_add_u32 s40, s40, 0
  v_add_u32 v217, s40, v250
  ds_write_b128 v217, v[32:35] offset:0
  ds_write_b128 v217, v[36:39] offset:1024
  ds_write_b128 v217, v[40:43] offset:2048
  ds_write_b128 v217, v[44:47] offset:3072
  s_xor_b32 s40, s33, 2
  s_mul_i32 s40, s40, 12288
  s_add_u32 s40, s40, 4096
  v_add_u32 v218, s40, v250
  ds_write_b128 v218, v[48:51] offset:0
  ds_write_b128 v218, v[52:55] offset:1024
  ds_write_b128 v218, v[56:59] offset:2048
  ds_write_b128 v218, v[60:63] offset:3072
  s_xor_b32 s40, s33, 3
  s_mul_i32 s40, s40, 12288
  s_add_u32 s40, s40, 8192
  v_add_u32 v219, s40, v250
  ds_write_b128 v219, v[64:67] offset:0
  ds_write_b128 v219, v[68:71] offset:1024
  ds_write_b128 v219, v[72:75] offset:2048
  ds_write_b128 v219, v[76:79] offset:3072
  v_mov_b32 v2, 157664
  v_mov_b32 v3, 1
  s_waitcnt lgkmcnt(0)
  s_mov_b64 exec, 1
  ds_add_u32 v2, v3
  s_mov_b64 exec, -1
  s_waitcnt vmcnt(8) lgkmcnt(0)
  v_mfma_f32_32x32x16_bf16 v[80:95], v[208:211], v[152:155], v[80:95]
  ds_read_b64_tr_b16 v[200:201], v252 offset:10240
  ds_read_b64_tr_b16 v[202:203], v252 offset:11264
  ds_read_b64_tr_b16 v[204:205], v253 offset:10240
  ds_read_b64_tr_b16 v[206:207], v253 offset:11264
  s_add_u32 m0, s67, 6144
  s_add_u32 s40, s97, 16384
  buffer_load_dwordx4 v251, s[20:23], s40 offen lds
  v_mfma_f32_32x32x16_bf16 v[96:111], v[212:215], v[152:155], v[96:111]
  buffer_load_dwordx4 v249, s[20:23], s40 offen offset:1024 lds
  v_mfma_f32_32x32x16_bf16 v[112:127], v[208:211], v[156:159], v[112:127]
  buffer_load_dwordx4 v[176:179], v250, s[12:15], s50 offen offset:0 sc1
  v_mfma_f32_32x32x16_bf16 v[128:143], v[212:215], v[156:159], v[128:143]
  buffer_load_dwordx4 v[180:183], v250, s[12:15], s51 offen offset:0 sc1
  s_waitcnt vmcnt(8) lgkmcnt(0)
  v_mfma_f32_32x32x16_bf16 v[80:95], v[200:203], v[160:163], v[80:95]
  ds_read_b64_tr_b16 v[208:209], v252 offset:12288
  ds_read_b64_tr_b16 v[210:211], v252 offset:13312
  ds_read_b64_tr_b16 v[212:213], v253 offset:12288
  ds_read_b64_tr_b16 v[214:215], v253 offset:13312
  buffer_load_dwordx4 v[184:187], v250, s[12:15], s50 offen offset:1024 sc1
  v_mfma_f32_32x32x16_bf16 v[96:111], v[204:207], v[160:163], v[96:111]
  buffer_load_dwordx4 v[188:191], v250, s[12:15], s51 offen offset:1024 sc1
  v_mfma_f32_32x32x16_bf16 v[112:127], v[200:203], v[164:167], v[112:127]
  v_mfma_f32_32x32x16_bf16 v[128:143], v[204:207], v[164:167], v[128:143]
  s_waitcnt vmcnt(6) lgkmcnt(0)
  v_mfma_f32_32x32x16_bf16 v[80:95], v[208:211], v[168:171], v[80:95]
  ds_read_b64_tr_b16 v[200:201], v252 offset:0
  ds_read_b64_tr_b16 v[202:203], v252 offset:1024
  ds_read_b64_tr_b16 v[204:205], v253 offset:0
  ds_read_b64_tr_b16 v[206:207], v253 offset:1024
  buffer_load_dwordx4 v[192:195], v250, s[12:15], s52 offen offset:0 sc1
  v_mfma_f32_32x32x16_bf16 v[96:111], v[212:215], v[168:171], v[96:111]
  buffer_load_dwordx4 v[196:199], v250, s[12:15], s53 offen offset:0 sc1
  v_mfma_f32_32x32x16_bf16 v[112:127], v[208:211], v[172:175], v[112:127]
  v_mfma_f32_32x32x16_bf16 v[128:143], v[212:215], v[172:175], v[128:143]
  s_waitcnt vmcnt(4) lgkmcnt(0)
  v_mfma_f32_32x32x16_bf16 v[80:95], v[200:203], v[176:179], v[80:95]
  ds_read_b64_tr_b16 v[208:209], v252 offset:2048
  ds_read_b64_tr_b16 v[210:211], v252 offset:3072
  ds_read_b64_tr_b16 v[212:213], v253 offset:2048
  ds_read_b64_tr_b16 v[214:215], v253 offset:3072
  buffer_load_dwordx4 v[144:147], v250, s[12:15], s52 offen offset:1024 sc1
  v_mfma_f32_32x32x16_bf16 v[96:111], v[204:207], v[176:179], v[96:111]
  buffer_load_dwordx4 v[148:151], v250, s[12:15], s53 offen offset:1024 sc1
  v_mfma_f32_32x32x16_bf16 v[112:127], v[200:203], v[180:183], v[112:127]
  v_mfma_f32_32x32x16_bf16 v[128:143], v[204:207], v[180:183], v[128:143]
  v_mov_b32 v2, 157664
  s_mov_b32 s3, 0
L_cw_29:
  ds_read_b32 v3, v2
  s_waitcnt lgkmcnt(0)
  v_readfirstlane_b32 s43, v3
  s_nop 0
  s_cmp_ge_u32 s43, 4
  s_cbranch_scc1 L_cw_29x
  s_sleep 1
  s_add_u32 s3, s3, 1
  s_cmp_gt_u32 s3, 160000
  s_cbranch_scc0 L_cw_29
L_cw_29x:
  s_mul_i32 s40, s33, 12288
  s_add_u32 s40, s40, 0
  v_add_u32 v216, s40, v250
  ds_read_b128 v[32:35], v216 offset:0
  ds_read_b128 v[36:39], v216 offset:1024
  ds_read_b128 v[40:43], v216 offset:2048
  ds_read_b128 v[44:47], v216 offset:3072
  ds_read_b128 v[48:51], v216 offset:4096
  ds_read_b128 v[52:55], v216 offset:5120
  ds_read_b128 v[56:59], v216 offset:6144
  ds_read_b128 v[60:63], v216 offset:7168
  ds_read_b128 v[64:67], v216 offset:8192
  ds_read_b128 v[68:71], v216 offset:9216
  ds_read_b128 v[72:75], v216 offset:10240
  ds_read_b128 v[76:79], v216 offset:11264
  s_waitcnt vmcnt(4) lgkmcnt(0)
  v_mfma_f32_32x32x16_bf16 v[80:95], v[208:211], v[184:187], v[80:95]
  ds_read_b64_tr_b16 v[200:201], v252 offset:4096
  ds_read_b64_tr_b16 v[202:203], v252 offset:5120
  ds_read_b64_tr_b16 v[204:205], v253 offset:4096
  ds_read_b64_tr_b16 v[206:207], v253 offset:5120
  v_mfma_f32_32x32x16_bf16 v[96:111], v[212:215], v[184:187], v[96:111]
  v_mfma_f32_32x32x16_bf16 v[112:127], v[208:211], v[188:191], v[112:127]
  v_mfma_f32_32x32x16_bf16 v[128:143], v[212:215], v[188:191], v[128:143]
  v_add_f32 v16, v16, v32
  v_add_f32 v17, v17, v33
  v_add_f32 v18, v18, v34
  v_add_f32 v19, v19, v35
  v_add_f32 v20, v20, v36
  v_add_f32 v21, v21, v37
  v_add_f32 v22, v22, v38
  v_add_f32 v23, v23, v39
  v_add_f32 v24, v24, v40
  v_add_f32 v25, v25, v41
  v_add_f32 v26, v26, v42
  v_add_f32 v27, v27, v43
  v_add_f32 v28, v28, v44
  v_add_f32 v29, v29, v45
  v_add_f32 v30, v30, v46
  v_add_f32 v31, v31, v47
  v_add_f32 v16, v16, v48
  v_add_f32 v17, v17, v49
  v_add_f32 v18, v18, v50
  v_add_f32 v19, v19, v51
  v_add_f32 v20, v20, v52
  v_add_f32 v21, v21, v53
  v_add_f32 v22, v22, v54
  v_add_f32 v23, v23, v55
  v_add_f32 v24, v24, v56
  v_add_f32 v25, v25, v57
  v_add_f32 v26, v26, v58
  v_add_f32 v27, v27, v59
  v_add_f32 v28, v28, v60
  v_add_f32 v29, v29, v61
  v_add_f32 v30, v30, v62
  v_add_f32 v31, v31, v63
  v_add_f32 v16, v16, v64
  v_add_f32 v17, v17, v65
  v_add_f32 v18, v18, v66
  v_add_f32 v19, v19, v67
  v_add_f32 v20, v20, v68
  v_add_f32 v21, v21, v69
  v_add_f32 v22, v22, v70
  v_add_f32 v23, v23, v71
  v_add_f32 v24, v24, v72
  v_add_f32 v25, v25, v73
  v_add_f32 v26, v26, v74
  v_add_f32 v27, v27, v75
  v_add_f32 v28, v28, v76
  v_add_f32 v29, v29, v77
  v_add_f32 v30, v30, v78
  v_add_f32 v31, v31, v79
  v_exp_f32 v32, -v16
  v_exp_f32 v33, -v17
  v_exp_f32 v34, -v18
  v_exp_f32 v35, -v19
  v_exp_f32 v36, -v20
  v_exp_f32 v37, -v21
  v_exp_f32 v38, -v22
  v_exp_f32 v39, -v23
  v_exp_f32 v40, -v24
  v_exp_f32 v41, -v25
  v_exp_f32 v42, -v26
  v_exp_f32 v43, -v27
  v_exp_f32 v44, -v28
  v_exp_f32 v45, -v29
  v_exp_f32 v46, -v30
  v_exp_f32 v47, -v31
  v_add_f32 v32, 1.0, v32
  v_add_f32 v33, 1.0, v33
  v_add_f32 v34, 1.0, v34
  v_add_f32 v35, 1.0, v35
  v_add_f32 v36, 1.0, v36
  v_add_f32 v37, 1.0, v37
  v_add_f32 v38, 1.0, v38
  v_add_f32 v39, 1.0, v39
  v_add_f32 v40, 1.0, v40
  v_add_f32 v41, 1.0, v41
  v_add_f32 v42, 1.0, v42
  v_add_f32 v43, 1.0, v43
  v_add_f32 v44, 1.0, v44
  v_add_f32 v45, 1.0, v45
  v_add_f32 v46, 1.0, v46
  v_add_f32 v47, 1.0, v47
  v_rcp_f32 v32, v32
  v_rcp_f32 v33, v33
  v_rcp_f32 v34, v34
  v_rcp_f32 v35, v35
  v_rcp_f32 v36, v36
  v_rcp_f32 v37, v37
  v_rcp_f32 v38, v38
  v_rcp_f32 v39, v39
  v_rcp_f32 v40, v40
  v_rcp_f32 v41, v41
  v_rcp_f32 v42, v42
  v_rcp_f32 v43, v43
  v_rcp_f32 v44, v44
  v_rcp_f32 v45, v45
  v_rcp_f32 v46, v46
  v_rcp_f32 v47, v47
  v_mul_f32 v16, v16, v32
  v_mul_f32 v17, v17, v33
  v_mul_f32 v18, v18, v34
  v_mul_f32 v19, v19, v35
  v_mul_f32 v20, v20, v36
  v_mul_f32 v21, v21, v37
  v_mul_f32 v22, v22, v38
  v_mul_f32 v23, v23, v39
  v_mul_f32 v24, v24, v40
  v_mul_f32 v25, v25, v41
  v_mul_f32 v26, v26, v42
  v_mul_f32 v27, v27, v43
  v_mul_f32 v28, v28, v44
  v_mul_f32 v29, v29, v45
  v_mul_f32 v30, v30, v46
  v_mul_f32 v31, v31, v47
  s_waitcnt vmcnt(2) lgkmcnt(0)
  v_mfma_f32_32x32x16_bf16 v[80:95], v[200:203], v[192:195], v[80:95]
  ds_read_b64_tr_b16 v[208:209], v252 offset:6144
  ds_read_b64_tr_b16 v[210:211], v252 offset:7168
  ds_read_b64_tr_b16 v[212:213], v253 offset:6144
  ds_read_b64_tr_b16 v[214:215], v253 offset:7168
  v_mfma_f32_32x32x16_bf16 v[96:111], v[204:207], v[192:195], v[96:111]
  v_mfma_f32_32x32x16_bf16 v[112:127], v[200:203], v[196:199], v[112:127]
  v_mfma_f32_32x32x16_bf16 v[128:143], v[204:207], v[196:199], v[128:143]
  s_waitcnt vmcnt(0) lgkmcnt(0)
  v_mfma_f32_32x32x16_bf16 v[80:95], v[208:211], v[144:147], v[80:95]
  v_mfma_f32_32x32x16_bf16 v[96:111], v[212:215], v[144:147], v[96:111]
  v_mfma_f32_32x32x16_bf16 v[112:127], v[208:211], v[148:151], v[112:127]
  v_mfma_f32_32x32x16_bf16 v[128:143], v[212:215], v[148:151], v[128:143]
L_FINAL:
  s_xor_b32 s40, s33, 1
  s_mul_i32 s40, s40, 12288
  s_add_u32 s40, s40, 49152
  v_add_u32 v217, s40, v250
  s_nop 5
  ds_write_b128 v217, v[96:99] offset:0
  ds_write_b128 v217, v[100:103] offset:1024
  ds_write_b128 v217, v[104:107] offset:2048
  ds_write_b128 v217, v[108:111] offset:3072
  s_xor_b32 s40, s33, 2
  s_mul_i32 s40, s40, 12288
  s_add_u32 s40, s40, 53248
  v_add_u32 v218, s40, v250
  ds_write_b128 v218, v[112:115] offset:0
  ds_write_b128 v218, v[116:119] offset:1024
  ds_write_b128 v218, v[120:123] offset:2048
  ds_write_b128 v218, v[124:127] offset:3072
  s_xor_b32 s40, s33, 3
  s_mul_i32 s40, s40, 12288
  s_add_u32 s40, s40, 57344
  v_add_u32 v219, s40, v250
  ds_write_b128 v219, v[128:131] offset:0
  ds_write_b128 v219, v[132:135] offset:1024
  ds_write_b128 v219, v[136:139] offset:2048
  ds_write_b128 v219, v[140:143] offset:3072
  v_mov_b32 v2, 157668
  v_mov_b32 v3, 1
  s_waitcnt lgkmcnt(0)
  s_mov_b64 exec, 1
  ds_add_u32 v2, v3
  s_mov_b64 exec, -1
  v_permlane32_swap_b32 v240, v242
  v_permlane32_swap_b32 v241, v243
  v_permlane32_swap_b32 v244, v246
  v_permlane32_swap_b32 v245, v247
  v_mov_b32 v2, 157668
  s_mov_b32 s3, 0
L_cw_30:
  ds_read_b32 v3, v2
  s_waitcnt lgkmcnt(0)
  v_readfirstlane_b32 s43, v3
  s_nop 0
  s_cmp_ge_u32 s43, 4
  s_cbranch_scc1 L_cw_30x
  s_sleep 1
  s_add_u32 s3, s3, 1
  s_cmp_gt_u32 s3, 160000
  s_cbranch_scc0 L_cw_30
L_cw_30x:
  s_mul_i32 s40, s33, 12288
  s_add_u32 s40, s40, 49152
  v_add_u32 v216, s40, v250
  ds_read_b128 v[144:147], v216 offset:0
  ds_read_b128 v[148:151], v216 offset:1024
  ds_read_b128 v[152:155], v216 offset:2048
  ds_read_b128 v[156:159], v216 offset:3072
  ds_read_b128 v[160:163], v216 offset:4096
  ds_read_b128 v[164:167], v216 offset:5120
  ds_read_b128 v[168:171], v216 offset:6144
  ds_read_b128 v[172:175], v216 offset:7168
  ds_read_b128 v[176:179], v216 offset:8192
  ds_read_b128 v[180:183], v216 offset:9216
  ds_read_b128 v[184:187], v216 offset:10240
  ds_read_b128 v[188:191], v216 offset:11264
  s_lshl_b32 s40, s62, 6
  s_lshr_b32 s41, s33, 1
  s_lshl_b32 s41, s41, 5
  s_add_u32 s40, s40, s41
  s_lshl_b32 s40, s40, 10
  s_lshl_b32 s41, s63, 7
  s_add_u32 s40, s40, s41
  s_and_b32 s41, s33, 1
  s_lshl_b32 s41, s41, 6
  s_add_u32 s40, s40, s41
  s_mov_b32 s41, 0x3ef5fdf0
  s_waitcnt lgkmcnt(8)
  v_add_f32 v80, v80, v144
  v_add_f32 v81, v81, v145
  v_add_f32 v82, v82, v146
  v_add_f32 v83, v83, v147
  v_add_f32 v84, v84, v148
  v_add_f32 v85, v85, v149
  v_add_f32 v86, v86, v150
  v_add_f32 v87, v87, v151
  v_add_f32 v88, v88, v152
  v_add_f32 v89, v89, v153
  v_add_f32 v90, v90, v154
  v_add_f32 v91, v91, v155
  v_add_f32 v92, v92, v156
  v_add_f32 v93, v93, v157
  v_add_f32 v94, v94, v158
  v_add_f32 v95, v95, v159
  s_waitcnt lgkmcnt(4)
  v_add_f32 v80, v80, v160
  v_add_f32 v81, v81, v161
  v_add_f32 v82, v82, v162
  v_add_f32 v83, v83, v163
  v_add_f32 v84, v84, v164
  v_add_f32 v85, v85, v165
  v_add_f32 v86, v86, v166
  v_add_f32 v87, v87, v167
  v_add_f32 v88, v88, v168
  v_add_f32 v89, v89, v169
  v_add_f32 v90, v90, v170
  v_add_f32 v91, v91, v171
  v_add_f32 v92, v92, v172
  v_add_f32 v93, v93, v173
  v_add_f32 v94, v94, v174
  v_add_f32 v95, v95, v175
  s_waitcnt lgkmcnt(0)
  v_add_f32 v80, v80, v176
  v_add_f32 v81, v81, v177
  v_add_f32 v82, v82, v178
  v_add_f32 v83, v83, v179
  v_add_f32 v84, v84, v180
  v_add_f32 v85, v85, v181
  v_add_f32 v86, v86, v182
  v_add_f32 v87, v87, v183
  v_add_f32 v88, v88, v184
  v_add_f32 v89, v89, v185
  v_add_f32 v90, v90, v186
  v_add_f32 v91, v91, v187
  v_add_f32 v92, v92, v188
  v_add_f32 v93, v93, v189
  v_add_f32 v94, v94, v190
  v_add_f32 v95, v95, v191
  v_mul_f32 v16, v16, v80
  v_mul_f32 v17, v17, v81
  v_mul_f32 v18, v18, v82
  v_mul_f32 v19, v19, v83
  v_mul_f32 v20, v20, v84
  v_mul_f32 v21, v21, v85
  v_mul_f32 v22, v22, v86
  v_mul_f32 v23, v23, v87
  v_mul_f32 v24, v24, v88
  v_mul_f32 v25, v25, v89
  v_mul_f32 v26, v26, v90
  v_mul_f32 v27, v27, v91
  v_mul_f32 v28, v28, v92
  v_mul_f32 v29, v29, v93
  v_mul_f32 v30, v30, v94
  v_mul_f32 v31, v31, v95
  v_lshlrev_b32 v144, 16, v240
  v_and_b32 v145, 0xffff0000, v240
  v_lshlrev_b32 v146, 16, v241
  v_and_b32 v147, 0xffff0000, v241
  v_lshlrev_b32 v148, 16, v242
  v_and_b32 v149, 0xffff0000, v242
  v_lshlrev_b32 v150, 16, v243
  v_and_b32 v151, 0xffff0000, v243
  v_fma_f32 v144, v16, s41, v144
  v_fma_f32 v145, v17, s41, v145
  v_fma_f32 v146, v18, s41, v146
  v_fma_f32 v147, v19, s41, v147
  v_fma_f32 v148, v20, s41, v148
  v_fma_f32 v149, v21, s41, v149
  v_fma_f32 v150, v22, s41, v150
  v_fma_f32 v151, v23, s41, v151
  v_cvt_pk_bf16_f32 v240, v144, v145
  v_cvt_pk_bf16_f32 v241, v146, v147
  v_cvt_pk_bf16_f32 v242, v148, v149
  v_cvt_pk_bf16_f32 v243, v150, v151
  s_nop 0
  v_permlane32_swap_b32 v240, v242
  v_permlane32_swap_b32 v241, v243
  buffer_store_dwordx4 v[240:243], v254, s[24:27], s40 offen offset:0
  v_lshlrev_b32 v144, 16, v244
  v_and_b32 v145, 0xffff0000, v244
  v_lshlrev_b32 v146, 16, v245
  v_and_b32 v147, 0xffff0000, v245
  v_lshlrev_b32 v148, 16, v246
  v_and_b32 v149, 0xffff0000, v246
  v_lshlrev_b32 v150, 16, v247
  v_and_b32 v151, 0xffff0000, v247
  v_fma_f32 v144, v24, s41, v144
  v_fma_f32 v145, v25, s41, v145
  v_fma_f32 v146, v26, s41, v146
  v_fma_f32 v147, v27, s41, v147
  v_fma_f32 v148, v28, s41, v148
  v_fma_f32 v149, v29, s41, v149
  v_fma_f32 v150, v30, s41, v150
  v_fma_f32 v151, v31, s41, v151
  v_cvt_pk_bf16_f32 v244, v144, v145
  v_cvt_pk_bf16_f32 v245, v146, v147
  v_cvt_pk_bf16_f32 v246, v148, v149
  v_cvt_pk_bf16_f32 v247, v150, v151
  s_nop 0
  v_permlane32_swap_b32 v244, v246
  v_permlane32_swap_b32 v245, v247
  buffer_store_dwordx4 v[244:247], v254, s[24:27], s40 offen offset:32
L_end:
  s_endpgm

.section .rodata,"a"
.p2align 6
.amdhsa_kernel recurrent_scan__linear_attn_block__dense_activation_silu__prompt_kernel
  .amdhsa_next_free_vgpr 256
  .amdhsa_next_free_sgpr 102
  .amdhsa_accum_offset 256
  .amdhsa_group_segment_fixed_size 0
  .amdhsa_kernarg_size 72
  .amdhsa_user_sgpr_count 2
  .amdhsa_user_sgpr_kernarg_segment_ptr 1
  .amdhsa_system_sgpr_workgroup_id_x 1
  .amdhsa_float_denorm_mode_32 3
  .amdhsa_float_denorm_mode_16_64 3
.end_amdhsa_kernel
```
